```python
import torch

def _softmax(x, axis=-1):
    return torch.softmax(x, dim=axis)
def _gelu(x):
    return torch.nn.functional.gelu(x, approximate="tanh")
def _silu(x):
    return torch.nn.functional.silu(x)
def _sigmoid(x):
    return torch.sigmoid(x)
def _layernorm(x, axis=-1, eps=1e-5):
    m = x.mean(dim=axis, keepdim=True)
    v = x.var(dim=axis, keepdim=True, unbiased=False)
    return (x - m) / torch.sqrt(v + eps)
def _scatter_add(tgt, idx, src, axis=0):
    return tgt.clone().index_add_(axis, idx, src)
def _segment_sum(src, seg, n):
    out = torch.zeros((n,) + src.shape[1:], dtype=src.dtype)
    return out.index_add_(0, seg, src)
def _pad(x, pw):
    flat = tuple(v for pair in reversed(pw) for v in pair)
    return torch.nn.functional.pad(x, flat)

kernel_name = 'recurrent_scan__sliding_block_cached__geglu_ffn__decode'

def setup_inputs():

    _w = (lambda a: (lambda t: t.to(torch.bfloat16) if t.is_floating_point() else t)(torch.as_tensor(a)))
    def _A_setup():
        B, Sq, D = 1, 1, 640
        Hq, Hkv, Sk, Dh = 32, 32, 32768, 192
        assert Hq % Hkv == 0, (Hq, Hkv)
        return {
            "x": _w((lambda *s: torch.randn(*s, dtype=torch.bfloat16) * 0.05)(B, Sq, D)),
            "k_cache": _w((lambda *s: torch.randn(*s, dtype=torch.bfloat16) * 1.6)(B, Hkv, Sk, Dh)),
            "v_cache": _w((lambda *s: torch.randn(*s, dtype=torch.bfloat16) * 0.2)(B, Hkv, Sk, Dh)),
            "wq": _w((lambda *s: torch.randn(*s, dtype=torch.bfloat16) * 1.6)(D, Hq * Dh) * (D ** -0.5)),
            "wo": _w((lambda *s: torch.randn(*s, dtype=torch.bfloat16) * 0.2)(Hq * Dh, D) * ((Hq * Dh) ** -0.5)),
        }
    _A_in = _A_setup()

    def _B_setup():
        B, S, D, F = 1, 1, 640, 1536
        return {
            "x": _w((lambda *s: torch.randn(*s, dtype=torch.bfloat16) * 0.05)(B, S, D)),
            "w_gate": _w((lambda *s: torch.randn(*s, dtype=torch.bfloat16) * 0.1)(D, F)),
            "w_up": _w((lambda *s: torch.randn(*s, dtype=torch.bfloat16) * 0.1)(D, F)),
            "w_down": _w((lambda *s: torch.randn(*s, dtype=torch.bfloat16) * 0.1)(F, D)),
        }
    _B_in = _B_setup()

    return {
        "A_x": _A_in["x"],
        "A_k_cache": _A_in["k_cache"],
        "A_v_cache": _A_in["v_cache"],
        "A_wq": _A_in["wq"],
        "A_wo": _A_in["wo"],
        "B_x": _B_in["x"],
        "B_w_gate": _B_in["w_gate"],
        "B_w_up": _B_in["w_up"],
        "B_w_down": _B_in["w_down"],
    }

def reference(A_x, A_k_cache, A_v_cache, A_wq, A_wo, B_x, B_w_gate, B_w_up, B_w_down):
    def _A_ref(x, k_cache, v_cache, wq, wo):
        B, Sq, D = x.shape
        Hq, Dh = 32, 192
        Hkv, Sk = k_cache.shape[1], k_cache.shape[2]
        W = min(4096, max(256, Sk // 4))
        rep = Hq // Hkv
        q = (lambda x, *d: x.permute(*d))((x @ wq).reshape(B, Sq, Hq, Dh), 0, 2, 1, 3)
        k = (lambda x, n, axis: torch.repeat_interleave(x, n, dim=axis))(k_cache[:, :, Sk - W:, :], rep, axis=1)
        v = (lambda x, n, axis: torch.repeat_interleave(x, n, dim=axis))(v_cache[:, :, Sk - W:, :], rep, axis=1)
        scores = torch.einsum("bhqd,bhkd->bhqk", q, k) * (Dh ** -0.5)
        p = _softmax(scores, axis=-1)
        o = torch.einsum("bhqk,bhkd->bhqd", p, v)
        return (lambda x, *d: x.permute(*d))(o, 0, 2, 1, 3).reshape(B, Sq, Hq * Dh) @ wo

    def _B_ref(x, w_gate, w_up, w_down):
        return (_gelu(x @ w_gate) * (x @ w_up)) @ w_down

    x = A_x
    xn = _layernorm(x, axis=-1)
    s = _A_ref(xn, A_k_cache, A_v_cache, A_wq, A_wo)
    g = _silu(_B_ref(xn, B_w_gate, B_w_up, B_w_down))
    return x + s * g
```

```asm
; @launch grid=(256,1,1) block=(512,1,1) lds=38912
.amdgcn_target "amdgcn-amd-amdhsa--gfx950"
.text
.globl recurrent_scan__sliding_block_cached__geglu_ffn__decode_kernel
.p2align 8
.type recurrent_scan__sliding_block_cached__geglu_ffn__decode_kernel,@function
recurrent_scan__sliding_block_cached__geglu_ffn__decode_kernel:
    s_cmp_ge_u32 s2, 256
    s_cbranch_scc1 L_end
    s_load_dwordx16 s[16:31], s[0:1], 0
    s_load_dwordx8 s[32:39], s[0:1], 64
    v_lshrrev_b32 v1, 6, v0
    v_and_b32 v2, 63, v0
    v_readfirstlane_b32 s3, v1
    s_and_b32 s4, s2, 31
    s_lshr_b32 s5, s2, 5
    s_lshr_b32 s84, s2, 3
    s_and_b32 s85, s2, 7
    v_lshlrev_b32 v3, 2, v2
    v_mul_u32_u24 v15, 20, v2
    v_lshrrev_b32 v21, 5, v2
    v_and_b32 v6, 31, v2
    v_lshlrev_b32 v7, 4, v6
    v_mul_u32_u24 v8, 12288, v21
    v_add_u32 v10, v8, v7
    v_mul_u32_u24 v8, 3072, v21
    v_add_u32 v11, v8, v7
    v_mov_b32 v9, 2147483648
    v_cmp_le_u32 vcc, 24, v6
    s_nop 1
    v_cndmask_b32 v10, v10, v9, vcc
    v_cndmask_b32 v11, v11, v9, vcc
    v_cmp_le_u32 vcc, 32, v2
    s_nop 1
    v_cndmask_b32 v12, v11, v9, vcc
    s_and_b32 s7, s2, 7
    s_mul_i32 s82, s7, 80
    s_mul_i32 s81, s3, 10
    s_add_u32 s82, s82, s81
    s_mul_i32 s83, s82, 12288
    s_lshr_b32 s81, s2, 3
    s_mul_i32 s81, s81, 384
    s_add_u32 s83, s83, s81
    s_bfe_u32 s8, s2, 0x10006
    s_lshl_b32 s8, s8, 3
    s_or_b32 s8, s8, s7
    s_bfe_u32 s9, s2, 0x30003
    s_lshr_b32 s10, s2, 7
    s_mul_i32 s11, s8, 40
    s_mul_i32 s81, s3, 5
    s_add_u32 s11, s11, s81
    s_mul_i32 s12, s11, 3072
    s_mul_i32 s81, s9, 384
    s_add_u32 s12, s12, s81
    v_lshrrev_b32 v5, 3, v2
    v_and_b32 v6, 7, v2
    v_mul_u32_u24 v5, 384, v5
    v_lshl_add_u32 v4, v6, 4, v5
    s_mul_i32 s80, s4, 12582912
    s_mul_i32 s81, s5, 196608
    s_add_u32 s80, s80, s81
    s_mul_i32 s81, s3, 3072
    s_add_u32 s80, s80, s81
    s_add_u32 s80, s80, 11010048
    v_lshrrev_b32 v5, 3, v2
    v_and_b32 v6, 7, v2
    v_mul_u32_u24 v7, 1280, v5
    v_lshl_add_u32 v14, v6, 4, v7
    v_mul_u32_u24 v7, 3840, v5
    v_lshl_add_u32 v13, v6, 4, v7
    v_cmp_le_u32 vcc, 48, v2
    s_nop 1
    v_cndmask_b32 v14, v14, v9, vcc
    v_mov_b32 v5, 21376
    v_mov_b32 v6, 0
    ds_write_b32 v5, v6
    ds_write_b32 v5, v6 offset:4
    s_waitcnt lgkmcnt(0)
    s_mov_b32 s68, s16
    s_mov_b32 s69, s17
    s_mov_b32 s70, 1280
    s_mov_b32 s71, 0x00020000
    buffer_load_dwordx4 v[16:19], v15, s[68:71], 0 offen
    buffer_load_dword v20, v15, s[68:71], 0 offen offset:16
    s_mov_b32 s48, s22
    s_mov_b32 s49, s23
    s_mov_b32 s50, 7864320
    s_mov_b32 s51, 0x00020000
    s_cmp_eq_u32 s10, 0
    s_cselect_b32 s56, s28, s30
    s_cselect_b32 s57, s29, s31
    s_mov_b32 s58, 1966080
    s_mov_b32 s59, 0x00020000
    s_mov_b32 s40, s18
    s_mov_b32 s41, s19
    s_mov_b32 s42, 402653184
    s_mov_b32 s43, 0x00020000
    s_mov_b32 s64, s38
    s_mov_b32 s65, s39
    s_mov_b32 s66, 2097152
    s_mov_b32 s67, 0x00020000
    s_cmp_lt_u32 s3, 6
    s_cbranch_scc1 L_noclr_1
    v_mov_b32 v224, -1
    v_mov_b32 v225, -1
    v_mov_b32 v226, -1
    v_mov_b32 v227, -1
    s_lshl_b32 s6, s4, 3
    s_add_u32 s6, s6, s5
    s_lshl_b32 s6, s6, 10
    s_add_u32 s6, s6, 524288
    s_lshl_b32 s7, s85, 5
    s_add_u32 s7, s7, s84
    s_lshl_b32 s7, s7, 10
    s_add_u32 s7, s7, 786432
    s_and_b32 s14, s85, 5
    s_cmp_eq_u32 s14, 0
    s_cselect_b32 s14, 63, 31
    s_cmp_eq_u32 s3, 6
    s_cselect_b32 s6, s6, s7
    s_cselect_b32 s7, 63, s14
    v_min_u32 v6, s7, v2
    v_lshlrev_b32 v6, 4, v6
    buffer_store_dwordx4 v[224:227], v6, s[64:67], s6 offen sc1
    s_cmp_eq_u32 s3, 6
    s_cbranch_scc1 L_noclr_1
    s_add_u32 s6, s6, 1048576
    buffer_store_dwordx4 v[224:227], v6, s[64:67], s6 offen sc1
L_noclr_1:
    s_nop 4
    s_barrier
    s_add_u32 s81, s83, 0
    buffer_load_dwordx4 v[32:35], v10, s[48:51], s81 offen nt
    s_add_u32 s81, s83, 24576
    buffer_load_dwordx4 v[36:39], v10, s[48:51], s81 offen nt
    s_add_u32 s81, s83, 49152
    buffer_load_dwordx4 v[40:43], v10, s[48:51], s81 offen nt
    s_add_u32 s81, s83, 73728
    buffer_load_dwordx4 v[44:47], v10, s[48:51], s81 offen nt
    s_add_u32 s81, s83, 98304
    buffer_load_dwordx4 v[48:51], v10, s[48:51], s81 offen nt
    s_add_u32 s81, s12, 0
    buffer_load_dwordx4 v[52:55], v11, s[56:59], s81 offen nt
    s_mov_b32 s44, s20
    s_mov_b32 s45, s21
    s_mov_b32 s46, 402653184
    s_mov_b32 s47, 0x00020000
    s_mov_b32 s52, s24
    s_mov_b32 s53, s25
    s_mov_b32 s54, 7864320
    s_mov_b32 s55, 0x00020000
    s_mov_b32 s60, s32
    s_mov_b32 s61, s33
    s_mov_b32 s62, 1966080
    s_mov_b32 s63, 0x00020000
    s_mov_b32 s72, s34
    s_mov_b32 s73, s35
    s_mov_b32 s74, 1280
    s_mov_b32 s75, 0x00020000
    s_mov_b32 s76, s36
    s_mov_b32 s77, s37
    s_mov_b32 s78, 256
    s_mov_b32 s79, 0x00020000
    s_waitcnt vmcnt(6)
    v_lshlrev_b32 v22, 16, v16
    v_and_b32 v23, 0xffff0000, v16
    v_lshlrev_b32 v24, 16, v17
    v_and_b32 v25, 0xffff0000, v17
    v_lshlrev_b32 v26, 16, v18
    v_and_b32 v27, 0xffff0000, v18
    v_lshlrev_b32 v28, 16, v19
    v_and_b32 v29, 0xffff0000, v19
    v_lshlrev_b32 v30, 16, v20
    v_and_b32 v31, 0xffff0000, v20
    v_add_f32 v5, v22, v23
    v_add_f32 v5, v5, v24
    v_add_f32 v5, v5, v25
    v_add_f32 v5, v5, v26
    v_add_f32 v5, v5, v27
    v_add_f32 v5, v5, v28
    v_add_f32 v5, v5, v29
    v_add_f32 v5, v5, v30
    v_add_f32 v5, v5, v31
    s_nop 1
    v_add_f32_dpp v5, v5, v5 quad_perm:[1,0,3,2] row_mask:0xf bank_mask:0xf
    s_nop 1
    v_add_f32_dpp v5, v5, v5 quad_perm:[2,3,0,1] row_mask:0xf bank_mask:0xf
    s_nop 1
    v_add_f32_dpp v5, v5, v5 row_half_mirror row_mask:0xf bank_mask:0xf
    s_nop 1
    v_add_f32_dpp v5, v5, v5 row_ror:8 row_mask:0xf bank_mask:0xf
    v_mov_b32 v6, v5
    s_nop 1
    v_permlane16_swap_b32 v5, v6
    v_add_f32 v5, v5, v6
    v_mov_b32 v6, v5
    s_nop 1
    v_permlane32_swap_b32 v5, v6
    v_add_f32 v5, v5, v6
    v_mul_f32 v5, 0x3acccccd, v5
    v_sub_f32 v6, v22, v5
    v_mul_f32 v7, v6, v6
    v_sub_f32 v6, v23, v5
    v_fmac_f32 v7, v6, v6
    v_sub_f32 v6, v24, v5
    v_fmac_f32 v7, v6, v6
    v_sub_f32 v6, v25, v5
    v_fmac_f32 v7, v6, v6
    v_sub_f32 v6, v26, v5
    v_fmac_f32 v7, v6, v6
    v_sub_f32 v6, v27, v5
    v_fmac_f32 v7, v6, v6
    v_sub_f32 v6, v28, v5
    v_fmac_f32 v7, v6, v6
    v_sub_f32 v6, v29, v5
    v_fmac_f32 v7, v6, v6
    v_sub_f32 v6, v30, v5
    v_fmac_f32 v7, v6, v6
    v_sub_f32 v6, v31, v5
    v_fmac_f32 v7, v6, v6
    s_nop 1
    v_add_f32_dpp v7, v7, v7 quad_perm:[1,0,3,2] row_mask:0xf bank_mask:0xf
    s_nop 1
    v_add_f32_dpp v7, v7, v7 quad_perm:[2,3,0,1] row_mask:0xf bank_mask:0xf
    s_nop 1
    v_add_f32_dpp v7, v7, v7 row_half_mirror row_mask:0xf bank_mask:0xf
    s_nop 1
    v_add_f32_dpp v7, v7, v7 row_ror:8 row_mask:0xf bank_mask:0xf
    v_mov_b32 v6, v7
    s_nop 1
    v_permlane16_swap_b32 v7, v6
    v_add_f32 v7, v7, v6
    v_mov_b32 v6, v7
    s_nop 1
    v_permlane32_swap_b32 v7, v6
    v_add_f32 v7, v7, v6
    s_waitcnt vmcnt(5)
    s_add_u32 s81, s12, 6144
    buffer_load_dwordx4 v[56:59], v11, s[56:59], s81 offen nt
    v_mul_f32 v7, 0x3acccccd, v7
    v_cvt_pk_bf16_f32 v6, v7, v5
    v_lshlrev_b32 v7, 16, v6
    v_and_b32 v5, 0xffff0000, v6
    v_add_f32 v7, 0x3727c5ac, v7
    v_cvt_pk_bf16_f32 v7, v7, v7
    v_and_b32 v7, 0xffff0000, v7
    v_sqrt_f32 v7, v7
    s_nop 0
    v_cvt_pk_bf16_f32 v7, v7, v7
    v_and_b32 v7, 0xffff0000, v7
    v_rcp_f32 v8, v7
    v_sub_f32 v22, v22, v5
    v_sub_f32 v23, v23, v5
    v_sub_f32 v24, v24, v5
    v_sub_f32 v25, v25, v5
    v_sub_f32 v26, v26, v5
    v_sub_f32 v27, v27, v5
    v_sub_f32 v28, v28, v5
    v_sub_f32 v29, v29, v5
    v_sub_f32 v30, v30, v5
    v_sub_f32 v31, v31, v5
    v_cvt_pk_bf16_f32 v6, v22, v23
    v_lshlrev_b32 v22, 16, v6
    v_and_b32 v23, 0xffff0000, v6
    v_cvt_pk_bf16_f32 v6, v24, v25
    v_lshlrev_b32 v24, 16, v6
    v_and_b32 v25, 0xffff0000, v6
    v_cvt_pk_bf16_f32 v6, v26, v27
    v_lshlrev_b32 v26, 16, v6
    v_and_b32 v27, 0xffff0000, v6
    v_cvt_pk_bf16_f32 v6, v28, v29
    v_lshlrev_b32 v28, 16, v6
    v_and_b32 v29, 0xffff0000, v6
    v_cvt_pk_bf16_f32 v6, v30, v31
    v_lshlrev_b32 v30, 16, v6
    v_and_b32 v31, 0xffff0000, v6
    v_mul_f32 v22, v22, v8
    v_mul_f32 v23, v23, v8
    v_mul_f32 v24, v24, v8
    v_mul_f32 v25, v25, v8
    v_mul_f32 v26, v26, v8
    v_mul_f32 v27, v27, v8
    v_mul_f32 v28, v28, v8
    v_mul_f32 v29, v29, v8
    v_mul_f32 v30, v30, v8
    v_mul_f32 v31, v31, v8
    v_cvt_pk_bf16_f32 v6, v22, v23
    v_lshlrev_b32 v22, 16, v6
    v_and_b32 v23, 0xffff0000, v6
    v_cvt_pk_bf16_f32 v6, v24, v25
    v_lshlrev_b32 v24, 16, v6
    v_and_b32 v25, 0xffff0000, v6
    v_cvt_pk_bf16_f32 v6, v26, v27
    v_lshlrev_b32 v26, 16, v6
    v_and_b32 v27, 0xffff0000, v6
    v_cvt_pk_bf16_f32 v6, v28, v29
    v_lshlrev_b32 v28, 16, v6
    v_and_b32 v29, 0xffff0000, v6
    v_cvt_pk_bf16_f32 v6, v30, v31
    v_lshlrev_b32 v30, 16, v6
    s_waitcnt vmcnt(5)
    s_add_u32 s81, s12, 12288
    buffer_load_dwordx4 v[60:63], v12, s[56:59], s81 offen nt
    v_and_b32 v31, 0xffff0000, v6
    v_mul_u32_u24 v6, 40, v2
    ds_write_b64 v6, v[22:23] offset:0
    ds_write_b64 v6, v[24:25] offset:8
    ds_write_b64 v6, v[26:27] offset:16
    ds_write_b64 v6, v[28:29] offset:24
    ds_write_b64 v6, v[30:31] offset:32
    v_add_u32 v5, s82, v21
    v_lshlrev_b32 v5, 2, v5
    v_add_u32 v6, s11, v21
    v_lshlrev_b32 v6, 2, v6
    s_waitcnt lgkmcnt(0)
    ds_read_b32 v16, v5 offset:0
    ds_read_b32 v17, v5 offset:8
    ds_read_b32 v18, v5 offset:16
    ds_read_b32 v19, v5 offset:24
    ds_read_b32 v20, v5 offset:32
    ds_read_b32 v22, v6 offset:0
    ds_read_b32 v23, v6 offset:8
    ds_read_b32 v24, v6 offset:16
    s_waitcnt lgkmcnt(0)
    v_cmp_eq_u32 vcc, 0, v21
    s_nop 1
    v_cndmask_b32 v24, 0, v24, vcc
    v_lshrrev_b32 v25, 16, v16
    v_lshrrev_b32 v26, 16, v17
    v_lshrrev_b32 v27, 16, v18
    v_lshrrev_b32 v28, 16, v19
    v_lshrrev_b32 v29, 16, v20
    v_lshrrev_b32 v30, 16, v22
    v_lshrrev_b32 v31, 16, v23
    v_lshrrev_b32 v15, 16, v24
    s_waitcnt vmcnt(5)
    s_add_u32 s81, s80, 0
    buffer_load_dwordx4 v[64:67], v4, s[40:43], s81 offen offset:0 nt
    s_waitcnt vmcnt(5)
    s_add_u32 s81, s80, 0
    buffer_load_dwordx4 v[68:71], v4, s[40:43], s81 offen offset:128 nt
    s_waitcnt vmcnt(5)
    s_add_u32 s81, s80, 0
    buffer_load_dwordx4 v[72:75], v4, s[40:43], s81 offen offset:256 nt
    v_dot2_f32_bf16 v248, v32, v25, 0
    v_dot2_f32_bf16 v249, v32, v16, 0
    v_dot2_f32_bf16 v250, v33, v25, 0
    v_dot2_f32_bf16 v251, v33, v16, 0
    v_dot2_f32_bf16 v252, v34, v25, 0
    v_dot2_f32_bf16 v253, v34, v16, 0
    v_dot2_f32_bf16 v254, v35, v25, 0
    v_dot2_f32_bf16 v255, v35, v16, 0
    v_dot2_f32_bf16 v248, v36, v26, v248
    v_dot2_f32_bf16 v249, v36, v17, v249
    v_dot2_f32_bf16 v250, v37, v26, v250
    v_dot2_f32_bf16 v251, v37, v17, v251
    v_dot2_f32_bf16 v252, v38, v26, v252
    v_dot2_f32_bf16 v253, v38, v17, v253
    v_dot2_f32_bf16 v254, v39, v26, v254
    v_dot2_f32_bf16 v255, v39, v17, v255
    v_dot2_f32_bf16 v248, v40, v27, v248
    v_dot2_f32_bf16 v249, v40, v18, v249
    v_dot2_f32_bf16 v250, v41, v27, v250
    v_dot2_f32_bf16 v251, v41, v18, v251
    v_dot2_f32_bf16 v252, v42, v27, v252
    v_dot2_f32_bf16 v253, v42, v18, v253
    v_dot2_f32_bf16 v254, v43, v27, v254
    v_dot2_f32_bf16 v255, v43, v18, v255
    v_dot2_f32_bf16 v248, v44, v28, v248
    v_dot2_f32_bf16 v249, v44, v19, v249
    v_dot2_f32_bf16 v250, v45, v28, v250
    v_dot2_f32_bf16 v251, v45, v19, v251
    v_dot2_f32_bf16 v252, v46, v28, v252
    v_dot2_f32_bf16 v253, v46, v19, v253
    v_dot2_f32_bf16 v254, v47, v28, v254
    v_dot2_f32_bf16 v255, v47, v19, v255
    v_dot2_f32_bf16 v248, v48, v29, v248
    v_dot2_f32_bf16 v249, v48, v20, v249
    v_dot2_f32_bf16 v250, v49, v29, v250
    v_dot2_f32_bf16 v251, v49, v20, v251
    v_dot2_f32_bf16 v252, v50, v29, v252
    v_dot2_f32_bf16 v253, v50, v20, v253
    v_dot2_f32_bf16 v254, v51, v29, v254
    v_dot2_f32_bf16 v255, v51, v20, v255
    s_waitcnt vmcnt(3)
    s_add_u32 s81, s80, 24576
    buffer_load_dwordx4 v[76:79], v4, s[40:43], s81 offen offset:0 nt
    v_dot2_f32_bf16 v232, v52, v30, 0
    v_dot2_f32_bf16 v233, v52, v22, 0
    v_dot2_f32_bf16 v234, v53, v30, 0
    v_dot2_f32_bf16 v235, v53, v22, 0
    v_dot2_f32_bf16 v236, v54, v30, 0
    v_dot2_f32_bf16 v237, v54, v22, 0
    v_dot2_f32_bf16 v238, v55, v30, 0
    v_dot2_f32_bf16 v239, v55, v22, 0
    v_dot2_f32_bf16 v232, v56, v31, v232
    v_dot2_f32_bf16 v233, v56, v23, v233
    v_dot2_f32_bf16 v234, v57, v31, v234
    v_dot2_f32_bf16 v235, v57, v23, v235
    v_dot2_f32_bf16 v236, v58, v31, v236
    v_dot2_f32_bf16 v237, v58, v23, v237
    v_dot2_f32_bf16 v238, v59, v31, v238
    v_dot2_f32_bf16 v239, v59, v23, v239
    v_dot2_f32_bf16 v232, v60, v15, v232
    v_dot2_f32_bf16 v233, v60, v24, v233
    v_dot2_f32_bf16 v234, v61, v15, v234
    v_dot2_f32_bf16 v235, v61, v24, v235
    v_dot2_f32_bf16 v236, v62, v15, v236
    v_dot2_f32_bf16 v237, v62, v24, v237
    v_dot2_f32_bf16 v238, v63, v15, v238
    v_dot2_f32_bf16 v239, v63, v24, v239
    v_permlane32_swap_b32 v248, v252
    v_permlane32_swap_b32 v249, v253
    v_permlane32_swap_b32 v250, v254
    v_permlane32_swap_b32 v251, v255
    v_permlane32_swap_b32 v232, v236
    v_permlane32_swap_b32 v233, v237
    v_permlane32_swap_b32 v234, v238
    v_permlane32_swap_b32 v235, v239
    v_add_f32 v248, v248, v252
    v_add_f32 v249, v249, v253
    v_add_f32 v250, v250, v254
    v_add_f32 v251, v251, v255
    v_add_f32 v232, v232, v236
    v_add_f32 v233, v233, v237
    v_add_f32 v234, v234, v238
    v_add_f32 v235, v235, v239
    s_waitcnt vmcnt(3)
    s_add_u32 s81, s80, 24576
    buffer_load_dwordx4 v[80:83], v4, s[40:43], s81 offen offset:128 nt
    v_and_b32 v6, 31, v2
    v_lshlrev_b32 v6, 5, v6
    v_lshl_add_u32 v6, v21, 4, v6
    s_mul_i32 s6, s3, 768
    v_add_u32 v6, s6, v6
    s_mov_b32 exec_lo, 0x00ffffff
    s_mov_b32 exec_hi, 0x00ffffff
    ds_write_b128 v6, v[248:251] offset:4096
    ds_write_b128 v6, v[232:235] offset:10240
    s_mov_b64 exec, 1
    v_mov_b32 v5, 21376
    v_mov_b32 v6, 1
    s_waitcnt lgkmcnt(0)
    ds_add_rtn_u32 v7, v5, v6
    s_waitcnt lgkmcnt(0)
    v_readfirstlane_b32 s13, v7
    s_mov_b64 exec, -1
    s_cmp_eq_u32 s13, 7
    s_cbranch_scc0 L_notlast_2
    v_min_u32 v5, 47, v2
    v_lshlrev_b32 v5, 4, v5
    s_mul_i32 s14, s2, 768
    s_add_u32 s14, s14, 0
    s_lshl_b32 s15, s10, 3
    s_add_u32 s15, s15, s9
    s_lshl_b32 s15, s15, 4
    s_add_u32 s15, s15, s8
    s_mul_i32 s15, s15, 768
    s_add_u32 s15, s15, 262144
    ds_read_b128 v[160:163], v5 offset:4096
    ds_read_b128 v[164:167], v5 offset:4864
    ds_read_b128 v[168:171], v5 offset:5632
    ds_read_b128 v[172:175], v5 offset:6400
    ds_read_b128 v[176:179], v5 offset:7168
    ds_read_b128 v[180:183], v5 offset:7936
    ds_read_b128 v[184:187], v5 offset:8704
    ds_read_b128 v[188:191], v5 offset:9472
    ds_read_b128 v[192:195], v5 offset:10240
    ds_read_b128 v[196:199], v5 offset:11008
    ds_read_b128 v[200:203], v5 offset:11776
    ds_read_b128 v[204:207], v5 offset:12544
    ds_read_b128 v[208:211], v5 offset:13312
    ds_read_b128 v[212:215], v5 offset:14080
    ds_read_b128 v[216:219], v5 offset:14848
    ds_read_b128 v[220:223], v5 offset:15616
    s_waitcnt lgkmcnt(0)
    v_add_f32 v160, v160, v176
    v_add_f32 v161, v161, v177
    v_add_f32 v162, v162, v178
    v_add_f32 v163, v163, v179
    v_add_f32 v164, v164, v180
    v_add_f32 v165, v165, v181
    v_add_f32 v166, v166, v182
    v_add_f32 v167, v167, v183
    v_add_f32 v168, v168, v184
    v_add_f32 v169, v169, v185
    v_add_f32 v170, v170, v186
    v_add_f32 v171, v171, v187
    v_add_f32 v172, v172, v188
    v_add_f32 v173, v173, v189
    v_add_f32 v174, v174, v190
    v_add_f32 v175, v175, v191
    v_add_f32 v160, v160, v168
    v_add_f32 v161, v161, v169
    v_add_f32 v162, v162, v170
    v_add_f32 v163, v163, v171
    v_add_f32 v164, v164, v172
    v_add_f32 v165, v165, v173
    v_add_f32 v166, v166, v174
    v_add_f32 v167, v167, v175
    v_add_f32 v160, v160, v164
    v_add_f32 v161, v161, v165
    v_add_f32 v162, v162, v166
    v_add_f32 v163, v163, v167
    buffer_store_dwordx4 v[160:163], v5, s[64:67], s14 offen sc1
    v_add_f32 v192, v192, v208
    v_add_f32 v193, v193, v209
    v_add_f32 v194, v194, v210
    v_add_f32 v195, v195, v211
    v_add_f32 v196, v196, v212
    v_add_f32 v197, v197, v213
    v_add_f32 v198, v198, v214
    v_add_f32 v199, v199, v215
    v_add_f32 v200, v200, v216
    v_add_f32 v201, v201, v217
    v_add_f32 v202, v202, v218
    v_add_f32 v203, v203, v219
    v_add_f32 v204, v204, v220
    v_add_f32 v205, v205, v221
    v_add_f32 v206, v206, v222
    v_add_f32 v207, v207, v223
    v_add_f32 v192, v192, v200
    v_add_f32 v193, v193, v201
    v_add_f32 v194, v194, v202
    v_add_f32 v195, v195, v203
    v_add_f32 v196, v196, v204
    v_add_f32 v197, v197, v205
    v_add_f32 v198, v198, v206
    v_add_f32 v199, v199, v207
    v_add_f32 v192, v192, v196
    v_add_f32 v193, v193, v197
    v_add_f32 v194, v194, v198
    v_add_f32 v195, v195, v199
    buffer_store_dwordx4 v[192:195], v5, s[64:67], s15 offen sc1
    s_add_u32 s81, s80, 24576
    buffer_load_dwordx4 v[84:87], v4, s[40:43], s81 offen offset:256 nt
    s_add_u32 s81, s80, 49152
    buffer_load_dwordx4 v[88:91], v4, s[40:43], s81 offen offset:0 nt
    s_add_u32 s81, s80, 49152
    buffer_load_dwordx4 v[92:95], v4, s[40:43], s81 offen offset:128 nt
    s_add_u32 s81, s80, 49152
    buffer_load_dwordx4 v[96:99], v4, s[40:43], s81 offen offset:256 nt
    s_waitcnt vmcnt(4)
    s_mov_b64 exec, 3
    s_lshr_b32 s6, s2, 3
    s_lshl_b32 s6, s6, 2
    v_mov_b32 v5, 128
    v_mov_b32 v7, s6
    v_cmp_eq_u32 vcc, 0, v2
    s_nop 1
    v_cndmask_b32 v5, v5, v7, vcc
    v_mov_b32 v6, 1
    buffer_atomic_add v6, v5, s[76:79], 0 offen sc1
    s_mov_b64 exec, -1
    s_add_u32 s81, s80, 73728
    buffer_load_dwordx4 v[100:103], v4, s[40:43], s81 offen offset:0 nt
    s_add_u32 s81, s80, 73728
    buffer_load_dwordx4 v[104:107], v4, s[40:43], s81 offen offset:128 nt
    s_add_u32 s81, s80, 73728
    buffer_load_dwordx4 v[108:111], v4, s[40:43], s81 offen offset:256 nt
    s_add_u32 s81, s80, 98304
    buffer_load_dwordx4 v[112:115], v4, s[40:43], s81 offen offset:0 nt
    s_branch L_join_3
L_notlast_2:
    s_nop 4
    s_waitcnt vmcnt(3)
    s_add_u32 s81, s80, 24576
    buffer_load_dwordx4 v[84:87], v4, s[40:43], s81 offen offset:256 nt
    s_waitcnt vmcnt(3)
    s_add_u32 s81, s80, 49152
    buffer_load_dwordx4 v[88:91], v4, s[40:43], s81 offen offset:0 nt
    s_waitcnt vmcnt(3)
    s_add_u32 s81, s80, 49152
    buffer_load_dwordx4 v[92:95], v4, s[40:43], s81 offen offset:128 nt
    s_waitcnt vmcnt(3)
    s_add_u32 s81, s80, 49152
    buffer_load_dwordx4 v[96:99], v4, s[40:43], s81 offen offset:256 nt
    s_waitcnt vmcnt(3)
    s_add_u32 s81, s80, 73728
    buffer_load_dwordx4 v[100:103], v4, s[40:43], s81 offen offset:0 nt
    s_waitcnt vmcnt(3)
    s_add_u32 s81, s80, 73728
    buffer_load_dwordx4 v[104:107], v4, s[40:43], s81 offen offset:128 nt
    s_waitcnt vmcnt(3)
    s_add_u32 s81, s80, 73728
    buffer_load_dwordx4 v[108:111], v4, s[40:43], s81 offen offset:256 nt
    s_waitcnt vmcnt(3)
    s_add_u32 s81, s80, 98304
    buffer_load_dwordx4 v[112:115], v4, s[40:43], s81 offen offset:0 nt
L_join_3:
    s_nop 4
    v_lshlrev_b32 v5, 7, v2
    s_lshl_b32 s6, s4, 2
    v_mov_b32 v7, s6
    v_cmp_eq_u32 vcc, 0, v2
    s_nop 1
    v_cndmask_b32 v5, v5, v7, vcc
    s_cmp_eq_u32 s3, 0
    s_cselect_b32 s6, 0, 2147483648
    v_add_u32 v11, s6, v5
    v_mov_b32 v5, 256
    v_mov_b32 v7, 8
    v_cmp_eq_u32 vcc, 0, v2
    s_nop 1
    v_cndmask_b32 v12, v5, v7, vcc
    s_mul_i32 s8, s84, 192
    s_mul_i32 s7, s3, 24
    s_add_u32 s8, s8, s7
    s_mul_i32 s8, s8, 1280
    s_mul_i32 s10, s84, 48
    s_mul_i32 s7, s3, 6
    s_add_u32 s10, s10, s7
    s_mul_i32 s10, s10, 1280
    s_lshr_b32 s7, s85, 1
    s_add_u32 s7, s7, 8
    s_lshl_b32 s7, s7, 7
    s_and_b32 s12, s85, 5
    s_cmp_eq_u32 s12, 0
    s_cselect_b32 s7, s7, 2147483648
    s_cselect_b32 s12, 1, 0
    s_add_u32 s9, s8, s7
    s_add_u32 s11, s10, s7
    s_lshl_b32 s7, s85, 7
    s_add_u32 s8, s8, s7
    s_add_u32 s10, s10, s7
    s_waitcnt vmcnt(3)
    s_add_u32 s81, s80, 98304
    buffer_load_dwordx4 v[116:119], v4, s[40:43], s81 offen offset:128 nt
    s_waitcnt vmcnt(3)
    s_add_u32 s81, s80, 98304
    buffer_load_dwordx4 v[120:123], v4, s[40:43], s81 offen offset:256 nt
    s_waitcnt vmcnt(3)
    s_add_u32 s81, s80, 122880
    buffer_load_dwordx4 v[124:127], v4, s[40:43], s81 offen offset:0 nt
    s_waitcnt vmcnt(3)
    s_add_u32 s81, s80, 122880
    buffer_load_dwordx4 v[128:131], v4, s[40:43], s81 offen offset:128 nt
    s_waitcnt vmcnt(3)
    s_add_u32 s81, s80, 122880
    buffer_load_dwordx4 v[132:135], v4, s[40:43], s81 offen offset:256 nt
    s_waitcnt vmcnt(3)
    s_add_u32 s81, s80, 147456
    buffer_load_dwordx4 v[136:139], v4, s[40:43], s81 offen offset:0 nt
    s_waitcnt vmcnt(3)
    s_add_u32 s81, s80, 147456
    buffer_load_dwordx4 v[140:143], v4, s[40:43], s81 offen offset:128 nt
    s_waitcnt vmcnt(3)
    s_add_u32 s81, s80, 147456
    buffer_load_dwordx4 v[144:147], v4, s[40:43], s81 offen offset:256 nt
    s_waitcnt vmcnt(3)
    s_add_u32 s81, s80, 172032
    buffer_load_dwordx4 v[148:151], v4, s[40:43], s81 offen offset:0 nt
    s_waitcnt vmcnt(3)
    s_add_u32 s81, s80, 172032
    buffer_load_dwordx4 v[152:155], v4, s[40:43], s81 offen offset:128 nt
    s_waitcnt vmcnt(3)
    s_add_u32 s81, s80, 172032
    buffer_load_dwordx4 v[156:159], v4, s[40:43], s81 offen offset:256 nt
    s_waitcnt vmcnt(3)
    s_add_u32 s81, s80, 0
    buffer_load_dwordx4 v[160:163], v4, s[44:47], s81 offen offset:0 nt
    s_waitcnt vmcnt(3)
    s_add_u32 s81, s80, 0
    buffer_load_dwordx4 v[164:167], v4, s[44:47], s81 offen offset:128 nt
    buffer_load_dword v1, v11, s[76:79], 0 offen sc1
    s_waitcnt vmcnt(3)
    s_add_u32 s81, s80, 0
    buffer_load_dwordx4 v[168:171], v4, s[44:47], s81 offen offset:256 nt
    s_waitcnt vmcnt(3)
    s_add_u32 s81, s80, 24576
    buffer_load_dwordx4 v[172:175], v4, s[44:47], s81 offen offset:0 nt
    s_waitcnt vmcnt(3)
    s_add_u32 s81, s80, 24576
    buffer_load_dwordx4 v[176:179], v4, s[44:47], s81 offen offset:128 nt
    s_waitcnt vmcnt(3)
    s_add_u32 s81, s80, 24576
    buffer_load_dwordx4 v[180:183], v4, s[44:47], s81 offen offset:256 nt
    s_cmp_lg_u32 s3, 0
    s_cbranch_scc1 L_fok_4
    s_mov_b32 s6, 65536
    v_cmp_gt_u32 vcc, v12, v1
    s_nop 0
    s_and_b32 s7, vcc_lo, 3
    s_cmp_eq_u32 s7, 0
    s_cbranch_scc1 L_fok_4
L_fpoll_5:
    s_nop 4
    s_sleep 8
    buffer_load_dword v1, v11, s[76:79], 0 offen sc1
    s_waitcnt vmcnt(0)
    s_sub_u32 s6, s6, 1
    s_cbranch_scc1 L_fok_4
    v_cmp_gt_u32 vcc, v12, v1
    s_nop 0
    s_and_b32 s7, vcc_lo, 3
    s_cmp_eq_u32 s7, 0
    s_cbranch_scc0 L_fpoll_5
L_fok_4:
    s_nop 4
    s_barrier
    v_lshrrev_b32 v5, 3, v2
    v_mul_u32_u24 v5, 768, v5
    v_and_b32 v6, 7, v2
    v_min_u32 v6, 5, v6
    v_lshl_add_u32 v5, v6, 4, v5
    s_mul_i32 s6, s4, 6144
    s_mul_i32 s7, s3, 96
    s_add_u32 s6, s6, s7
    s_add_u32 s6, s6, 0
    buffer_load_dwordx4 v[32:35], v5, s[64:67], s6 offen sc1
    s_cmp_ge_u32 s3, 6
    s_cselect_b32 s7, 6, 0
    s_sub_u32 s13, s3, s7
    v_lshrrev_b32 v5, 5, v2
    v_mul_u32_u24 v5, 98304, v5
    v_bfe_u32 v6, v2, 1, 4
    v_mul_u32_u24 v6, 768, v6
    v_add_u32 v5, v5, v6
    v_and_b32 v6, 1, v2
    v_lshl_add_u32 v5, v6, 4, v5
    s_lshr_b32 s6, s84, 2
    s_mul_i32 s6, s6, 12288
    s_and_b32 s7, s84, 3
    s_mul_i32 s7, s7, 192
    s_add_u32 s6, s6, s7
    s_lshl_b32 s7, s13, 5
    s_add_u32 s6, s6, s7
    s_add_u32 s6, s6, 262144
    buffer_load_dwordx4 v[36:39], v5, s[64:67], s6 offen sc1
    s_waitcnt vmcnt(3)
    s_add_u32 s81, s80, 49152
    buffer_load_dwordx4 v[184:187], v4, s[44:47], s81 offen offset:0 nt
    s_waitcnt vmcnt(3)
    s_add_u32 s81, s80, 49152
    buffer_load_dwordx4 v[188:191], v4, s[44:47], s81 offen offset:128 nt
    s_waitcnt vmcnt(3)
    s_add_u32 s81, s80, 49152
    buffer_load_dwordx4 v[192:195], v4, s[44:47], s81 offen offset:256 nt
    v_permlane32_swap_b32 v32, v34
    v_permlane32_swap_b32 v33, v35
    v_add_f32 v32, v32, v34
    v_add_f32 v33, v33, v35
    s_nop 1
    v_permlane16_swap_b32 v32, v33
    v_add_f32 v32, v32, v33
    s_nop 1
    v_add_f32_dpp v32, v32, v32 row_ror:8 row_mask:0xf bank_mask:0xf
    v_cvt_pk_bf16_f32 v32, v32, v32
    v_and_b32 v5, 7, v2
    v_min_u32 v5, 5, v5
    v_lshrrev_b32 v6, 4, v2
    v_lshl_add_u32 v5, v5, 2, v6
    s_mul_i32 s6, s3, 24
    v_add_u32 v5, s6, v5
    v_lshlrev_b32 v5, 1, v5
    ds_write_b16 v5, v32 offset:20480
    s_waitcnt vmcnt(3)
    s_add_u32 s81, s80, 73728
    buffer_load_dwordx4 v[196:199], v4, s[44:47], s81 offen offset:0 nt
    s_waitcnt lgkmcnt(0)
    s_barrier
    v_and_b32 v5, 7, v2
    v_lshlrev_b32 v5, 4, v5
    ds_read_b128 v[40:43], v5 offset:20480
    ds_read_b128 v[44:47], v5 offset:20608
    ds_read_b128 v[48:51], v5 offset:20736
    v_add_f32_dpp v36, v36, v36 quad_perm:[2,3,0,1] row_mask:0xf bank_mask:0xf
    v_add_f32_dpp v37, v37, v37 quad_perm:[2,3,0,1] row_mask:0xf bank_mask:0xf
    v_add_f32_dpp v38, v38, v38 quad_perm:[2,3,0,1] row_mask:0xf bank_mask:0xf
    v_add_f32_dpp v39, v39, v39 quad_perm:[2,3,0,1] row_mask:0xf bank_mask:0xf
    v_add_f32_dpp v36, v36, v36 row_ror:4 row_mask:0xf bank_mask:0xf
    v_add_f32_dpp v37, v37, v37 row_ror:4 row_mask:0xf bank_mask:0xf
    v_add_f32_dpp v38, v38, v38 row_ror:4 row_mask:0xf bank_mask:0xf
    v_add_f32_dpp v39, v39, v39 row_ror:4 row_mask:0xf bank_mask:0xf
    v_add_f32_dpp v36, v36, v36 row_ror:8 row_mask:0xf bank_mask:0xf
    v_add_f32_dpp v37, v37, v37 row_ror:8 row_mask:0xf bank_mask:0xf
    v_add_f32_dpp v38, v38, v38 row_ror:8 row_mask:0xf bank_mask:0xf
    v_add_f32_dpp v39, v39, v39 row_ror:8 row_mask:0xf bank_mask:0xf
    v_permlane16_swap_b32 v36, v37
    s_nop 0
    v_permlane16_swap_b32 v38, v39
    v_add_f32 v36, v36, v37
    v_add_f32 v38, v38, v39
    v_mov_b32 v37, v36
    v_mov_b32 v39, v38
    s_nop 0
    v_permlane32_swap_b32 v36, v37
    v_permlane32_swap_b32 v38, v39
    v_cvt_pk_bf16_f32 v5, v36, v37
    v_lshlrev_b32 v36, 16, v5
    v_and_b32 v37, 0xffff0000, v5
    v_mul_f32 v5, v36, v36
    v_mul_f32 v5, 0x3d372713, v5
    v_fma_f32 v5, v5, v36, v36
    v_mul_f32 v5, 0xc0135761, v5
    v_exp_f32 v5, v5
    s_nop 0
    v_add_f32 v5, 1.0, v5
    v_rcp_f32 v5, v5
    s_nop 0
    v_mul_f32 v36, v36, v5
    v_cvt_pk_bf16_f32 v36, v36, v36
    v_and_b32 v36, 0xffff0000, v36
    v_mul_f32 v36, v36, v37
    v_cvt_pk_bf16_f32 v36, v36, v36
    v_and_b32 v36, 0xffff0000, v36
    v_cvt_pk_bf16_f32 v5, v38, v39
    v_lshlrev_b32 v38, 16, v5
    v_and_b32 v39, 0xffff0000, v5
    v_mul_f32 v5, v38, v38
    v_mul_f32 v5, 0x3d372713, v5
    v_fma_f32 v5, v5, v38, v38
    v_mul_f32 v5, 0xc0135761, v5
    v_exp_f32 v5, v5
    s_nop 0
    v_add_f32 v5, 1.0, v5
    v_rcp_f32 v5, v5
    s_nop 0
    v_mul_f32 v38, v38, v5
    v_cvt_pk_bf16_f32 v38, v38, v38
    v_and_b32 v38, 0xffff0000, v38
    v_mul_f32 v38, v38, v39
    v_cvt_pk_bf16_f32 v38, v38, v38
    v_and_b32 v38, 0xffff0000, v38
    v_and_b32 v5, 1, v2
    v_lshlrev_b32 v5, 2, v5
    v_bfe_u32 v6, v2, 4, 1
    v_add_u32 v5, v5, v6
    s_lshl_b32 s6, s13, 3
    v_add_u32 v5, s6, v5
    v_lshlrev_b32 v5, 2, v5
    ds_write_b32 v5, v36 offset:20992
    ds_write_b32 v5, v38 offset:21000
    s_waitcnt lgkmcnt(0)
    s_waitcnt vmcnt(3)
    s_add_u32 s81, s80, 73728
    buffer_load_dwordx4 v[200:203], v4, s[44:47], s81 offen offset:128 nt
    s_waitcnt vmcnt(14)
    v_dot2_f32_bf16 v52, v64, v40, 0
    v_dot2_f32_bf16 v53, v76, v40, 0
    v_dot2_f32_bf16 v54, v88, v40, 0
    v_dot2_f32_bf16 v55, v100, v40, 0
    v_dot2_f32_bf16 v56, v112, v40, 0
    v_dot2_f32_bf16 v57, v124, v40, 0
    v_dot2_f32_bf16 v58, v136, v40, 0
    v_dot2_f32_bf16 v59, v148, v40, 0
    v_dot2_f32_bf16 v52, v65, v41, v52
    v_dot2_f32_bf16 v53, v77, v41, v53
    v_dot2_f32_bf16 v54, v89, v41, v54
    v_dot2_f32_bf16 v55, v101, v41, v55
    v_dot2_f32_bf16 v56, v113, v41, v56
    v_dot2_f32_bf16 v57, v125, v41, v57
    v_dot2_f32_bf16 v58, v137, v41, v58
    v_dot2_f32_bf16 v59, v149, v41, v59
    v_dot2_f32_bf16 v52, v66, v42, v52
    v_dot2_f32_bf16 v53, v78, v42, v53
    v_dot2_f32_bf16 v54, v90, v42, v54
    v_dot2_f32_bf16 v55, v102, v42, v55
    v_dot2_f32_bf16 v56, v114, v42, v56
    v_dot2_f32_bf16 v57, v126, v42, v57
    v_dot2_f32_bf16 v58, v138, v42, v58
    v_dot2_f32_bf16 v59, v150, v42, v59
    v_dot2_f32_bf16 v52, v67, v43, v52
    v_dot2_f32_bf16 v53, v79, v43, v53
    v_dot2_f32_bf16 v54, v91, v43, v54
    v_dot2_f32_bf16 v55, v103, v43, v55
    v_dot2_f32_bf16 v56, v115, v43, v56
    v_dot2_f32_bf16 v57, v127, v43, v57
    v_dot2_f32_bf16 v58, v139, v43, v58
    v_dot2_f32_bf16 v59, v151, v43, v59
    v_dot2_f32_bf16 v52, v68, v44, v52
    v_dot2_f32_bf16 v53, v80, v44, v53
    v_dot2_f32_bf16 v54, v92, v44, v54
    v_dot2_f32_bf16 v55, v104, v44, v55
    v_dot2_f32_bf16 v56, v116, v44, v56
    v_dot2_f32_bf16 v57, v128, v44, v57
    v_dot2_f32_bf16 v58, v140, v44, v58
    v_dot2_f32_bf16 v59, v152, v44, v59
    v_dot2_f32_bf16 v52, v69, v45, v52
    v_dot2_f32_bf16 v53, v81, v45, v53
    v_dot2_f32_bf16 v54, v93, v45, v54
    v_dot2_f32_bf16 v55, v105, v45, v55
    v_dot2_f32_bf16 v56, v117, v45, v56
    v_dot2_f32_bf16 v57, v129, v45, v57
    v_dot2_f32_bf16 v58, v141, v45, v58
    v_dot2_f32_bf16 v59, v153, v45, v59
    v_dot2_f32_bf16 v52, v70, v46, v52
    v_dot2_f32_bf16 v53, v82, v46, v53
    v_dot2_f32_bf16 v54, v94, v46, v54
    v_dot2_f32_bf16 v55, v106, v46, v55
    v_dot2_f32_bf16 v56, v118, v46, v56
    v_dot2_f32_bf16 v57, v130, v46, v57
    v_dot2_f32_bf16 v58, v142, v46, v58
    v_dot2_f32_bf16 v59, v154, v46, v59
    v_dot2_f32_bf16 v52, v71, v47, v52
    v_dot2_f32_bf16 v53, v83, v47, v53
    v_dot2_f32_bf16 v54, v95, v47, v54
    v_dot2_f32_bf16 v55, v107, v47, v55
    s_waitcnt vmcnt(3)
    s_add_u32 s81, s80, 73728
    buffer_load_dwordx4 v[204:207], v4, s[44:47], s81 offen offset:256 nt
    v_dot2_f32_bf16 v56, v119, v47, v56
    v_dot2_f32_bf16 v57, v131, v47, v57
    v_dot2_f32_bf16 v58, v143, v47, v58
    v_dot2_f32_bf16 v59, v155, v47, v59
    v_dot2_f32_bf16 v52, v72, v48, v52
    v_dot2_f32_bf16 v53, v84, v48, v53
    v_dot2_f32_bf16 v54, v96, v48, v54
    v_dot2_f32_bf16 v55, v108, v48, v55
    v_dot2_f32_bf16 v56, v120, v48, v56
    v_dot2_f32_bf16 v57, v132, v48, v57
    v_dot2_f32_bf16 v58, v144, v48, v58
    v_dot2_f32_bf16 v59, v156, v48, v59
    v_dot2_f32_bf16 v52, v73, v49, v52
    v_dot2_f32_bf16 v53, v85, v49, v53
    v_dot2_f32_bf16 v54, v97, v49, v54
    v_dot2_f32_bf16 v55, v109, v49, v55
    v_dot2_f32_bf16 v56, v121, v49, v56
    v_dot2_f32_bf16 v57, v133, v49, v57
    v_dot2_f32_bf16 v58, v145, v49, v58
    v_dot2_f32_bf16 v59, v157, v49, v59
    v_dot2_f32_bf16 v52, v74, v50, v52
    v_dot2_f32_bf16 v53, v86, v50, v53
    v_dot2_f32_bf16 v54, v98, v50, v54
    v_dot2_f32_bf16 v55, v110, v50, v55
    v_dot2_f32_bf16 v56, v122, v50, v56
    v_dot2_f32_bf16 v57, v134, v50, v57
    v_dot2_f32_bf16 v58, v146, v50, v58
    v_dot2_f32_bf16 v59, v158, v50, v59
    v_dot2_f32_bf16 v52, v75, v51, v52
    v_dot2_f32_bf16 v53, v87, v51, v53
    v_dot2_f32_bf16 v54, v99, v51, v54
    v_dot2_f32_bf16 v55, v111, v51, v55
    v_dot2_f32_bf16 v56, v123, v51, v56
    v_dot2_f32_bf16 v57, v135, v51, v57
    v_dot2_f32_bf16 v58, v147, v51, v58
    v_dot2_f32_bf16 v59, v159, v51, v59
    v_add_f32_dpp v52, v52, v52 quad_perm:[1,0,3,2] row_mask:0xf bank_mask:0xf
    v_add_f32_dpp v53, v53, v53 quad_perm:[1,0,3,2] row_mask:0xf bank_mask:0xf
    v_add_f32_dpp v54, v54, v54 quad_perm:[1,0,3,2] row_mask:0xf bank_mask:0xf
    v_add_f32_dpp v55, v55, v55 quad_perm:[1,0,3,2] row_mask:0xf bank_mask:0xf
    v_add_f32_dpp v56, v56, v56 quad_perm:[1,0,3,2] row_mask:0xf bank_mask:0xf
    v_add_f32_dpp v57, v57, v57 quad_perm:[1,0,3,2] row_mask:0xf bank_mask:0xf
    v_add_f32_dpp v58, v58, v58 quad_perm:[1,0,3,2] row_mask:0xf bank_mask:0xf
    v_add_f32_dpp v59, v59, v59 quad_perm:[1,0,3,2] row_mask:0xf bank_mask:0xf
    v_add_f32_dpp v52, v52, v52 quad_perm:[2,3,0,1] row_mask:0xf bank_mask:0xf
    v_add_f32_dpp v53, v53, v53 quad_perm:[2,3,0,1] row_mask:0xf bank_mask:0xf
    v_add_f32_dpp v54, v54, v54 quad_perm:[2,3,0,1] row_mask:0xf bank_mask:0xf
    v_add_f32_dpp v55, v55, v55 quad_perm:[2,3,0,1] row_mask:0xf bank_mask:0xf
    v_add_f32_dpp v56, v56, v56 quad_perm:[2,3,0,1] row_mask:0xf bank_mask:0xf
    v_add_f32_dpp v57, v57, v57 quad_perm:[2,3,0,1] row_mask:0xf bank_mask:0xf
    v_add_f32_dpp v58, v58, v58 quad_perm:[2,3,0,1] row_mask:0xf bank_mask:0xf
    v_add_f32_dpp v59, v59, v59 quad_perm:[2,3,0,1] row_mask:0xf bank_mask:0xf
    v_add_f32_dpp v52, v52, v52 row_half_mirror row_mask:0xf bank_mask:0xf
    v_add_f32_dpp v53, v53, v53 row_half_mirror row_mask:0xf bank_mask:0xf
    v_add_f32_dpp v54, v54, v54 row_half_mirror row_mask:0xf bank_mask:0xf
    v_add_f32_dpp v55, v55, v55 row_half_mirror row_mask:0xf bank_mask:0xf
    v_add_f32_dpp v56, v56, v56 row_half_mirror row_mask:0xf bank_mask:0xf
    v_add_f32_dpp v57, v57, v57 row_half_mirror row_mask:0xf bank_mask:0xf
    v_add_f32_dpp v58, v58, v58 row_half_mirror row_mask:0xf bank_mask:0xf
    v_add_f32_dpp v59, v59, v59 row_half_mirror row_mask:0xf bank_mask:0xf
    s_waitcnt vmcnt(3)
    s_add_u32 s81, s80, 98304
    buffer_load_dwordx4 v[208:211], v4, s[44:47], s81 offen offset:0 nt
    v_cvt_pk_bf16_f32 v5, v52, v53
    v_lshlrev_b32 v52, 16, v5
    v_and_b32 v53, 0xffff0000, v5
    v_cvt_pk_bf16_f32 v5, v54, v55
    v_lshlrev_b32 v54, 16, v5
    v_and_b32 v55, 0xffff0000, v5
    v_cvt_pk_bf16_f32 v5, v56, v57
    v_lshlrev_b32 v56, 16, v5
    v_and_b32 v57, 0xffff0000, v5
    v_cvt_pk_bf16_f32 v5, v58, v59
    v_lshlrev_b32 v58, 16, v5
    v_and_b32 v59, 0xffff0000, v5
    v_mul_f32 v52, 0x3d93cd3a, v52
    v_mul_f32 v53, 0x3d93cd3a, v53
    v_mul_f32 v54, 0x3d93cd3a, v54
    v_mul_f32 v55, 0x3d93cd3a, v55
    v_mul_f32 v56, 0x3d93cd3a, v56
    v_mul_f32 v57, 0x3d93cd3a, v57
    v_mul_f32 v58, 0x3d93cd3a, v58
    v_mul_f32 v59, 0x3d93cd3a, v59
    v_cvt_pk_bf16_f32 v5, v52, v53
    v_lshlrev_b32 v52, 16, v5
    v_and_b32 v53, 0xffff0000, v5
    v_cvt_pk_bf16_f32 v5, v54, v55
    v_lshlrev_b32 v54, 16, v5
    v_and_b32 v55, 0xffff0000, v5
    v_cvt_pk_bf16_f32 v5, v56, v57
    v_lshlrev_b32 v56, 16, v5
    v_and_b32 v57, 0xffff0000, v5
    v_cvt_pk_bf16_f32 v5, v58, v59
    v_lshlrev_b32 v58, 16, v5
    v_and_b32 v59, 0xffff0000, v5
    v_max3_f32 v5, v52, v53, v54
    v_max3_f32 v5, v5, v55, v56
    v_max3_f32 v5, v5, v57, v58
    v_max_f32 v5, v5, v59
    s_nop 1
    v_max_f32_dpp v5, v5, v5 row_ror:8 row_mask:0xf bank_mask:0xf
    v_mov_b32 v6, v5
    s_nop 1
    v_permlane16_swap_b32 v5, v6
    v_max_f32 v5, v5, v6
    v_mov_b32 v6, v5
    s_nop 1
    v_permlane32_swap_b32 v5, v6
    v_max_f32 v5, v5, v6
    s_lshl_b32 s6, s3, 2
    v_mov_b32 v6, s6
    ds_write_b32 v6, v5 offset:21248
    s_waitcnt lgkmcnt(0)
    s_barrier
    v_mov_b32 v6, 0
    ds_read_b128 v[32:35], v6 offset:21248
    ds_read_b128 v[36:39], v6 offset:21264
    s_waitcnt vmcnt(3)
    s_add_u32 s81, s80, 98304
    buffer_load_dwordx4 v[212:215], v4, s[44:47], s81 offen offset:128 nt
    s_waitcnt lgkmcnt(0)
    v_max3_f32 v5, v32, v33, v34
    v_max3_f32 v5, v5, v35, v36
    v_max3_f32 v5, v5, v37, v38
    v_max_f32 v15, v5, v39
    v_sub_f32 v52, v52, v15
    v_sub_f32 v53, v53, v15
    v_sub_f32 v54, v54, v15
    v_sub_f32 v55, v55, v15
    v_sub_f32 v56, v56, v15
    v_sub_f32 v57, v57, v15
    v_sub_f32 v58, v58, v15
    v_sub_f32 v59, v59, v15
    v_mul_f32 v52, 0x3fb8aa3b, v52
    v_mul_f32 v53, 0x3fb8aa3b, v53
    v_mul_f32 v54, 0x3fb8aa3b, v54
    v_mul_f32 v55, 0x3fb8aa3b, v55
    v_mul_f32 v56, 0x3fb8aa3b, v56
    v_mul_f32 v57, 0x3fb8aa3b, v57
    v_mul_f32 v58, 0x3fb8aa3b, v58
    v_mul_f32 v59, 0x3fb8aa3b, v59
    v_exp_f32 v52, v52
    v_exp_f32 v53, v53
    v_exp_f32 v54, v54
    v_exp_f32 v55, v55
    v_exp_f32 v56, v56
    v_exp_f32 v57, v57
    v_exp_f32 v58, v58
    v_exp_f32 v59, v59
    v_cvt_pk_bf16_f32 v5, v52, v53
    v_and_b32 v32, 0xffff, v5
    v_lshlrev_b32 v40, 16, v5
    v_lshrrev_b32 v33, 16, v5
    v_and_b32 v41, 0xffff0000, v5
    v_cvt_pk_bf16_f32 v5, v54, v55
    v_and_b32 v34, 0xffff, v5
    v_lshlrev_b32 v42, 16, v5
    v_lshrrev_b32 v35, 16, v5
    v_and_b32 v43, 0xffff0000, v5
    v_cvt_pk_bf16_f32 v5, v56, v57
    v_and_b32 v36, 0xffff, v5
    v_lshlrev_b32 v44, 16, v5
    v_lshrrev_b32 v37, 16, v5
    v_and_b32 v45, 0xffff0000, v5
    v_cvt_pk_bf16_f32 v5, v58, v59
    v_and_b32 v38, 0xffff, v5
    v_lshlrev_b32 v46, 16, v5
    v_lshrrev_b32 v39, 16, v5
    v_and_b32 v47, 0xffff0000, v5
    v_add_f32 v6, v52, v53
    v_add_f32 v6, v6, v54
    v_add_f32 v6, v6, v55
    v_add_f32 v6, v6, v56
    v_add_f32 v6, v6, v57
    v_add_f32 v6, v6, v58
    v_add_f32 v6, v6, v59
    s_nop 1
    v_add_f32_dpp v6, v6, v6 row_ror:8 row_mask:0xf bank_mask:0xf
    v_mov_b32 v7, v6
    s_nop 1
    v_permlane16_swap_b32 v6, v7
    v_add_f32 v6, v6, v7
    v_mov_b32 v7, v6
    s_nop 1
    v_permlane32_swap_b32 v6, v7
    v_add_f32 v6, v6, v7
    s_cmp_eq_u32 s3, 0
    s_cselect_b32 s6, 1.0, 0
    s_waitcnt vmcnt(3)
    s_add_u32 s81, s80, 98304
    buffer_load_dwordx4 v[216:219], v4, s[44:47], s81 offen offset:256 nt
    v_mul_f32 v7, s6, v15
    v_and_b32 v5, 1, v2
    v_cmp_eq_u32 vcc, 1, v5
    s_nop 1
    v_cndmask_b32 v7, v7, v6, vcc
    v_lshlrev_b32 v5, 4, v2
    s_lshl_b32 s6, s3, 10
    v_add_u32 v5, s6, v5
    ds_write_b32 v5, v7 offset:22540
    v_and_b32 v5, 7, v2
    v_lshlrev_b32 v5, 3, v5
    v_lshrrev_b32 v6, 5, v2
    v_lshl_add_u32 v5, v6, 2, v5
    v_bfe_u32 v6, v2, 4, 1
    v_lshl_add_u32 v5, v6, 1, v5
    v_add_u32 v6, 0, v5
    v_mul_u32_u24 v7, 43691, v6
    v_lshrrev_b32 v7, 17, v7
    v_add_u32 v6, v6, v7
    v_lshlrev_b32 v136, 2, v6
    v_add_u32 v136, s6, v136
    v_add_u32 v6, 1, v5
    v_mul_u32_u24 v7, 43691, v6
    v_lshrrev_b32 v7, 17, v7
    v_add_u32 v6, v6, v7
    v_lshlrev_b32 v137, 2, v6
    v_add_u32 v137, s6, v137
    v_add_u32 v6, 64, v5
    v_mul_u32_u24 v7, 43691, v6
    v_lshrrev_b32 v7, 17, v7
    v_add_u32 v6, v6, v7
    v_lshlrev_b32 v138, 2, v6
    v_add_u32 v138, s6, v138
    v_add_u32 v6, 65, v5
    v_mul_u32_u24 v7, 43691, v6
    v_lshrrev_b32 v7, 17, v7
    v_add_u32 v6, v6, v7
    v_lshlrev_b32 v139, 2, v6
    v_add_u32 v139, s6, v139
    v_add_u32 v6, 128, v5
    v_mul_u32_u24 v7, 43691, v6
    v_lshrrev_b32 v7, 17, v7
    v_add_u32 v6, v6, v7
    v_lshlrev_b32 v140, 2, v6
    v_add_u32 v140, s6, v140
    v_add_u32 v6, 129, v5
    v_mul_u32_u24 v7, 43691, v6
    v_lshrrev_b32 v7, 17, v7
    v_add_u32 v6, v6, v7
    v_lshlrev_b32 v141, 2, v6
    v_add_u32 v141, s6, v141
    s_waitcnt vmcnt(3)
    s_add_u32 s81, s80, 122880
    buffer_load_dwordx4 v[220:223], v4, s[44:47], s81 offen offset:0 nt
    s_waitcnt vmcnt(15)
    v_dot2_f32_bf16 v96, v160, v32, 0
    v_dot2_f32_bf16 v97, v160, v40, 0
    v_dot2_f32_bf16 v98, v161, v32, 0
    v_dot2_f32_bf16 v99, v161, v40, 0
    v_dot2_f32_bf16 v100, v162, v32, 0
    v_dot2_f32_bf16 v101, v162, v40, 0
    v_dot2_f32_bf16 v102, v163, v32, 0
    v_dot2_f32_bf16 v103, v163, v40, 0
    v_dot2_f32_bf16 v104, v164, v32, 0
    v_dot2_f32_bf16 v105, v164, v40, 0
    v_dot2_f32_bf16 v106, v165, v32, 0
    v_dot2_f32_bf16 v107, v165, v40, 0
    v_dot2_f32_bf16 v108, v166, v32, 0
    v_dot2_f32_bf16 v109, v166, v40, 0
    v_dot2_f32_bf16 v110, v167, v32, 0
    v_dot2_f32_bf16 v111, v167, v40, 0
    v_dot2_f32_bf16 v112, v168, v32, 0
    v_dot2_f32_bf16 v113, v168, v40, 0
    v_dot2_f32_bf16 v114, v169, v32, 0
    v_dot2_f32_bf16 v115, v169, v40, 0
    v_dot2_f32_bf16 v116, v170, v32, 0
    v_dot2_f32_bf16 v117, v170, v40, 0
    v_dot2_f32_bf16 v118, v171, v32, 0
    v_dot2_f32_bf16 v119, v171, v40, 0
    s_waitcnt vmcnt(3)
    s_add_u32 s81, s80, 122880
    buffer_load_dwordx4 v[224:227], v4, s[44:47], s81 offen offset:128 nt
    s_waitcnt vmcnt(13)
    v_dot2_f32_bf16 v96, v172, v33, v96
    v_dot2_f32_bf16 v97, v172, v41, v97
    v_dot2_f32_bf16 v98, v173, v33, v98
    v_dot2_f32_bf16 v99, v173, v41, v99
    v_dot2_f32_bf16 v100, v174, v33, v100
    v_dot2_f32_bf16 v101, v174, v41, v101
    v_dot2_f32_bf16 v102, v175, v33, v102
    v_dot2_f32_bf16 v103, v175, v41, v103
    v_dot2_f32_bf16 v104, v176, v33, v104
    v_dot2_f32_bf16 v105, v176, v41, v105
    v_dot2_f32_bf16 v106, v177, v33, v106
    v_dot2_f32_bf16 v107, v177, v41, v107
    v_dot2_f32_bf16 v108, v178, v33, v108
    v_dot2_f32_bf16 v109, v178, v41, v109
    v_dot2_f32_bf16 v110, v179, v33, v110
    v_dot2_f32_bf16 v111, v179, v41, v111
    v_dot2_f32_bf16 v112, v180, v33, v112
    v_dot2_f32_bf16 v113, v180, v41, v113
    v_dot2_f32_bf16 v114, v181, v33, v114
    v_dot2_f32_bf16 v115, v181, v41, v115
    v_dot2_f32_bf16 v116, v182, v33, v116
    v_dot2_f32_bf16 v117, v182, v41, v117
    v_dot2_f32_bf16 v118, v183, v33, v118
    v_dot2_f32_bf16 v119, v183, v41, v119
    s_waitcnt vmcnt(3)
    s_add_u32 s81, s80, 122880
    buffer_load_dwordx4 v[228:231], v4, s[44:47], s81 offen offset:256 nt
    s_waitcnt vmcnt(9)
    v_dot2_f32_bf16 v96, v184, v34, v96
    v_dot2_f32_bf16 v97, v184, v42, v97
    v_dot2_f32_bf16 v98, v185, v34, v98
    v_dot2_f32_bf16 v99, v185, v42, v99
    v_dot2_f32_bf16 v100, v186, v34, v100
    v_dot2_f32_bf16 v101, v186, v42, v101
    v_dot2_f32_bf16 v102, v187, v34, v102
    v_dot2_f32_bf16 v103, v187, v42, v103
    v_dot2_f32_bf16 v104, v188, v34, v104
    v_dot2_f32_bf16 v105, v188, v42, v105
    v_dot2_f32_bf16 v106, v189, v34, v106
    v_dot2_f32_bf16 v107, v189, v42, v107
    v_dot2_f32_bf16 v108, v190, v34, v108
    v_dot2_f32_bf16 v109, v190, v42, v109
    v_dot2_f32_bf16 v110, v191, v34, v110
    v_dot2_f32_bf16 v111, v191, v42, v111
    v_dot2_f32_bf16 v112, v192, v34, v112
    v_dot2_f32_bf16 v113, v192, v42, v113
    v_dot2_f32_bf16 v114, v193, v34, v114
    v_dot2_f32_bf16 v115, v193, v42, v115
    v_dot2_f32_bf16 v116, v194, v34, v116
    v_dot2_f32_bf16 v117, v194, v42, v117
    v_dot2_f32_bf16 v118, v195, v34, v118
    v_dot2_f32_bf16 v119, v195, v42, v119
    s_waitcnt vmcnt(3)
    s_add_u32 s81, s80, 147456
    buffer_load_dwordx4 v[232:235], v4, s[44:47], s81 offen offset:0 nt
    s_waitcnt vmcnt(7)
    v_dot2_f32_bf16 v96, v196, v35, v96
    v_dot2_f32_bf16 v97, v196, v43, v97
    v_dot2_f32_bf16 v98, v197, v35, v98
    v_dot2_f32_bf16 v99, v197, v43, v99
    v_dot2_f32_bf16 v100, v198, v35, v100
    v_dot2_f32_bf16 v101, v198, v43, v101
    v_dot2_f32_bf16 v102, v199, v35, v102
    v_dot2_f32_bf16 v103, v199, v43, v103
    v_dot2_f32_bf16 v104, v200, v35, v104
    v_dot2_f32_bf16 v105, v200, v43, v105
    v_dot2_f32_bf16 v106, v201, v35, v106
    v_dot2_f32_bf16 v107, v201, v43, v107
    v_dot2_f32_bf16 v108, v202, v35, v108
    v_dot2_f32_bf16 v109, v202, v43, v109
    v_dot2_f32_bf16 v110, v203, v35, v110
    v_dot2_f32_bf16 v111, v203, v43, v111
    v_dot2_f32_bf16 v112, v204, v35, v112
    v_dot2_f32_bf16 v113, v204, v43, v113
    v_dot2_f32_bf16 v114, v205, v35, v114
    v_dot2_f32_bf16 v115, v205, v43, v115
    v_dot2_f32_bf16 v116, v206, v35, v116
    v_dot2_f32_bf16 v117, v206, v43, v117
    v_dot2_f32_bf16 v118, v207, v35, v118
    v_dot2_f32_bf16 v119, v207, v43, v119
    s_waitcnt vmcnt(3)
    s_add_u32 s81, s80, 147456
    buffer_load_dwordx4 v[236:239], v4, s[44:47], s81 offen offset:128 nt
    s_waitcnt vmcnt(5)
    v_dot2_f32_bf16 v96, v208, v36, v96
    v_dot2_f32_bf16 v97, v208, v44, v97
    v_dot2_f32_bf16 v98, v209, v36, v98
    v_dot2_f32_bf16 v99, v209, v44, v99
    v_dot2_f32_bf16 v100, v210, v36, v100
    v_dot2_f32_bf16 v101, v210, v44, v101
    v_dot2_f32_bf16 v102, v211, v36, v102
    v_dot2_f32_bf16 v103, v211, v44, v103
    v_dot2_f32_bf16 v104, v212, v36, v104
    v_dot2_f32_bf16 v105, v212, v44, v105
    v_dot2_f32_bf16 v106, v213, v36, v106
    v_dot2_f32_bf16 v107, v213, v44, v107
    v_dot2_f32_bf16 v108, v214, v36, v108
    v_dot2_f32_bf16 v109, v214, v44, v109
    v_dot2_f32_bf16 v110, v215, v36, v110
    v_dot2_f32_bf16 v111, v215, v44, v111
    v_dot2_f32_bf16 v112, v216, v36, v112
    v_dot2_f32_bf16 v113, v216, v44, v113
    v_dot2_f32_bf16 v114, v217, v36, v114
    v_dot2_f32_bf16 v115, v217, v44, v115
    v_dot2_f32_bf16 v116, v218, v36, v116
    v_dot2_f32_bf16 v117, v218, v44, v117
    v_dot2_f32_bf16 v118, v219, v36, v118
    v_dot2_f32_bf16 v119, v219, v44, v119
    s_waitcnt vmcnt(3)
    s_add_u32 s81, s80, 147456
    buffer_load_dwordx4 v[240:243], v4, s[44:47], s81 offen offset:256 nt
    s_waitcnt vmcnt(3)
    s_add_u32 s81, s80, 172032
    buffer_load_dwordx4 v[244:247], v4, s[44:47], s81 offen offset:0 nt
    v_dot2_f32_bf16 v96, v220, v37, v96
    v_dot2_f32_bf16 v97, v220, v45, v97
    v_dot2_f32_bf16 v98, v221, v37, v98
    v_dot2_f32_bf16 v99, v221, v45, v99
    v_dot2_f32_bf16 v100, v222, v37, v100
    v_dot2_f32_bf16 v101, v222, v45, v101
    v_dot2_f32_bf16 v102, v223, v37, v102
    v_dot2_f32_bf16 v103, v223, v45, v103
    v_dot2_f32_bf16 v104, v224, v37, v104
    v_dot2_f32_bf16 v105, v224, v45, v105
    v_dot2_f32_bf16 v106, v225, v37, v106
    v_dot2_f32_bf16 v107, v225, v45, v107
    v_dot2_f32_bf16 v108, v226, v37, v108
    v_dot2_f32_bf16 v109, v226, v45, v109
    v_dot2_f32_bf16 v110, v227, v37, v110
    v_dot2_f32_bf16 v111, v227, v45, v111
    v_dot2_f32_bf16 v112, v228, v37, v112
    v_dot2_f32_bf16 v113, v228, v45, v113
    v_dot2_f32_bf16 v114, v229, v37, v114
    v_dot2_f32_bf16 v115, v229, v45, v115
    v_dot2_f32_bf16 v116, v230, v37, v116
    v_dot2_f32_bf16 v117, v230, v45, v117
    v_dot2_f32_bf16 v118, v231, v37, v118
    v_dot2_f32_bf16 v119, v231, v45, v119
    s_waitcnt vmcnt(3)
    s_add_u32 s81, s80, 172032
    buffer_load_dwordx4 v[248:251], v4, s[44:47], s81 offen offset:128 nt
    s_waitcnt vmcnt(3)
    s_add_u32 s81, s80, 172032
    buffer_load_dwordx4 v[252:255], v4, s[44:47], s81 offen offset:256 nt
    s_waitcnt vmcnt(3)
    buffer_load_dwordx4 v[92:95], v14, s[60:63], s11 offen nt
    v_dot2_f32_bf16 v96, v232, v38, v96
    v_dot2_f32_bf16 v97, v232, v46, v97
    v_dot2_f32_bf16 v98, v233, v38, v98
    v_dot2_f32_bf16 v99, v233, v46, v99
    v_dot2_f32_bf16 v100, v234, v38, v100
    v_dot2_f32_bf16 v101, v234, v46, v101
    v_dot2_f32_bf16 v102, v235, v38, v102
    v_dot2_f32_bf16 v103, v235, v46, v103
    v_dot2_f32_bf16 v104, v236, v38, v104
    v_dot2_f32_bf16 v105, v236, v46, v105
    v_dot2_f32_bf16 v106, v237, v38, v106
    v_dot2_f32_bf16 v107, v237, v46, v107
    v_dot2_f32_bf16 v108, v238, v38, v108
    v_dot2_f32_bf16 v109, v238, v46, v109
    v_dot2_f32_bf16 v110, v239, v38, v110
    v_dot2_f32_bf16 v111, v239, v46, v111
    v_dot2_f32_bf16 v112, v240, v38, v112
    v_dot2_f32_bf16 v113, v240, v46, v113
    v_dot2_f32_bf16 v114, v241, v38, v114
    v_dot2_f32_bf16 v115, v241, v46, v115
    v_dot2_f32_bf16 v116, v242, v38, v116
    v_dot2_f32_bf16 v117, v242, v46, v117
    v_dot2_f32_bf16 v118, v243, v38, v118
    v_dot2_f32_bf16 v119, v243, v46, v119
    s_waitcnt vmcnt(3)
    s_add_u32 s15, s9, 0
    buffer_load_dwordx4 v[80:83], v13, s[52:55], s15 offen nt
    s_lshl_b32 s14, s4, 3
    s_add_u32 s14, s14, s5
    s_lshl_b32 s14, s14, 10
    s_add_u32 s14, s14, 524288
    v_dot2_f32_bf16 v96, v244, v39, v96
    v_dot2_f32_bf16 v97, v244, v47, v97
    v_dot2_f32_bf16 v98, v245, v39, v98
    v_dot2_f32_bf16 v99, v245, v47, v99
    v_dot2_f32_bf16 v100, v246, v39, v100
    v_dot2_f32_bf16 v101, v246, v47, v101
    v_dot2_f32_bf16 v102, v247, v39, v102
    v_dot2_f32_bf16 v103, v247, v47, v103
    v_permlane32_swap_b32 v96, v100
    v_permlane32_swap_b32 v97, v101
    v_permlane32_swap_b32 v98, v102
    v_permlane32_swap_b32 v99, v103
    v_add_f32 v96, v96, v100
    v_add_f32 v97, v97, v101
    v_add_f32 v98, v98, v102
    v_add_f32 v99, v99, v103
    s_nop 0
    v_permlane16_swap_b32 v96, v98
    v_permlane16_swap_b32 v97, v99
    v_add_f32 v96, v96, v98
    v_add_f32 v97, v97, v99
    s_nop 0
    v_add_f32_dpp v96, v96, v96 row_ror:8 row_mask:0xf bank_mask:0xf
    v_add_f32_dpp v97, v97, v97 row_ror:8 row_mask:0xf bank_mask:0xf
    ds_write_b32 v136, v96 offset:22528
    ds_write_b32 v137, v97 offset:22528
    s_waitcnt vmcnt(3)
    s_add_u32 s15, s9, 1280
    buffer_load_dwordx4 v[84:87], v13, s[52:55], s15 offen nt
    v_dot2_f32_bf16 v104, v248, v39, v104
    v_dot2_f32_bf16 v105, v248, v47, v105
    v_dot2_f32_bf16 v106, v249, v39, v106
    v_dot2_f32_bf16 v107, v249, v47, v107
    v_dot2_f32_bf16 v108, v250, v39, v108
    v_dot2_f32_bf16 v109, v250, v47, v109
    v_dot2_f32_bf16 v110, v251, v39, v110
    v_dot2_f32_bf16 v111, v251, v47, v111
    v_permlane32_swap_b32 v104, v108
    v_permlane32_swap_b32 v105, v109
    v_permlane32_swap_b32 v106, v110
    v_permlane32_swap_b32 v107, v111
    v_add_f32 v104, v104, v108
    v_add_f32 v105, v105, v109
    v_add_f32 v106, v106, v110
    v_add_f32 v107, v107, v111
    s_nop 0
    v_permlane16_swap_b32 v104, v106
    v_permlane16_swap_b32 v105, v107
    v_add_f32 v104, v104, v106
    v_add_f32 v105, v105, v107
    s_nop 0
    v_add_f32_dpp v104, v104, v104 row_ror:8 row_mask:0xf bank_mask:0xf
    v_add_f32_dpp v105, v105, v105 row_ror:8 row_mask:0xf bank_mask:0xf
    ds_write_b32 v138, v104 offset:22528
    ds_write_b32 v139, v105 offset:22528
    s_add_u32 s15, s9, 2560
    buffer_load_dwordx4 v[88:91], v13, s[52:55], s15 offen nt
    buffer_load_dwordx4 v[76:79], v14, s[60:63], s10 offen nt
    s_add_u32 s15, s8, 0
    buffer_load_dwordx4 v[64:67], v13, s[52:55], s15 offen nt
    s_add_u32 s15, s8, 1280
    buffer_load_dwordx4 v[68:71], v13, s[52:55], s15 offen nt
    s_add_u32 s15, s8, 2560
    buffer_load_dwordx4 v[72:75], v13, s[52:55], s15 offen nt
    s_waitcnt vmcnt(8)
    v_dot2_f32_bf16 v112, v252, v39, v112
    v_dot2_f32_bf16 v113, v252, v47, v113
    v_dot2_f32_bf16 v114, v253, v39, v114
    v_dot2_f32_bf16 v115, v253, v47, v115
    v_dot2_f32_bf16 v116, v254, v39, v116
    v_dot2_f32_bf16 v117, v254, v47, v117
    v_dot2_f32_bf16 v118, v255, v39, v118
    v_dot2_f32_bf16 v119, v255, v47, v119
    v_permlane32_swap_b32 v112, v116
    v_permlane32_swap_b32 v113, v117
    v_permlane32_swap_b32 v114, v118
    v_permlane32_swap_b32 v115, v119
    v_add_f32 v112, v112, v116
    v_add_f32 v113, v113, v117
    v_add_f32 v114, v114, v118
    v_add_f32 v115, v115, v119
    s_nop 0
    v_permlane16_swap_b32 v112, v114
    v_permlane16_swap_b32 v113, v115
    v_add_f32 v112, v112, v114
    v_add_f32 v113, v113, v115
    s_nop 0
    v_add_f32_dpp v112, v112, v112 row_ror:8 row_mask:0xf bank_mask:0xf
    v_add_f32_dpp v113, v113, v113 row_ror:8 row_mask:0xf bank_mask:0xf
    ds_write_b32 v140, v112 offset:22528
    ds_write_b32 v141, v113 offset:22528
    s_lshl_b32 s6, s3, 8
    v_add_u32 v5, s6, v3
    s_waitcnt lgkmcnt(0)
    s_barrier
    s_cmp_gt_u32 s3, 3
    s_cbranch_scc1 L_gath_6
    ds_read_b32 v96, v5 offset:22528
    ds_read_b32 v97, v5 offset:23552
    ds_read_b32 v98, v5 offset:24576
    ds_read_b32 v99, v5 offset:25600
    ds_read_b32 v100, v5 offset:26624
    ds_read_b32 v101, v5 offset:27648
    ds_read_b32 v102, v5 offset:28672
    ds_read_b32 v103, v5 offset:29696
    s_waitcnt lgkmcnt(0)
    v_add_f32 v96, v96, v100
    v_add_f32 v97, v97, v101
    v_add_f32 v98, v98, v102
    v_add_f32 v99, v99, v103
    v_add_f32 v96, v96, v98
    v_add_f32 v97, v97, v99
    v_add_f32 v96, v96, v97
    v_min_u32 v96, -2, v96
    buffer_store_dword v96, v5, s[64:67], s14 offen sc1
L_gath_6:
    s_nop 4
    v_lshrrev_b32 v5, 3, v2
    s_mul_i32 s6, s3, 6
    v_add_u32 v6, s6, v5
    v_lshlrev_b32 v6, 2, v6
    ds_read_b32 v48, v6 offset:20992
    v_and_b32 v52, 7, v2
    v_lshlrev_b32 v52, 5, v52
    v_lshrrev_b32 v6, 5, v2
    v_lshl_add_u32 v52, v6, 4, v52
    v_bfe_u32 v6, v2, 4, 1
    v_lshl_add_u32 v52, v6, 3, v52
    s_lshl_b32 s6, s3, 10
    v_add_u32 v52, s6, v52
    v_and_b32 v6, 7, v2
    v_lshlrev_b32 v53, 10, v6
    v_lshl_add_u32 v54, v5, 4, v53
    s_lshl_b32 s6, s84, 13
    s_add_u32 s6, s6, 524288
    s_lshl_b32 s7, s3, 7
    s_add_u32 s7, s7, s6
    s_mov_b32 s81, 65536
    s_cmp_ge_u32 s84, 16
    s_cselect_b32 s14, 1, 0
    s_and_b32 s15, s84, 15
    s_lshr_b32 s13, s85, 1
    s_add_u32 s13, s13, 8
    s_cmp_eq_u32 s14, 1
    s_cselect_b32 s13, s13, s85
    s_lshl_b32 s13, s13, 6
    s_lshl_b32 s82, s15, 2
    s_add_u32 s13, s13, s82
    v_bfe_u32 v5, v2, 4, 1
    v_add_u32 v5, s13, v5
    v_lshlrev_b32 v9, 1, v5
    buffer_load_ushort v20, v9, s[68:71], 0 offen
    buffer_load_ushort v21, v9, s[68:71], 0 offen offset:4
    s_waitcnt lgkmcnt(0)
    v_cmp_gt_u32 vcc, 48, v2
    s_nop 1
    v_cndmask_b32 v48, 0, v48, vcc
    v_lshrrev_b32 v49, 16, v48
    s_waitcnt vmcnt(5)
    v_dot2_f32_bf16 v128, v76, v49, 0
    v_dot2_f32_bf16 v129, v76, v48, 0
    v_dot2_f32_bf16 v130, v77, v49, 0
    v_dot2_f32_bf16 v131, v77, v48, 0
    v_dot2_f32_bf16 v132, v78, v49, 0
    v_dot2_f32_bf16 v133, v78, v48, 0
    v_dot2_f32_bf16 v134, v79, v49, 0
    v_dot2_f32_bf16 v135, v79, v48, 0
    v_dot2_f32_bf16 v144, v92, v49, 0
    v_dot2_f32_bf16 v145, v92, v48, 0
    v_dot2_f32_bf16 v146, v93, v49, 0
    v_dot2_f32_bf16 v147, v93, v48, 0
    v_dot2_f32_bf16 v148, v94, v49, 0
    v_dot2_f32_bf16 v149, v94, v48, 0
    v_dot2_f32_bf16 v150, v95, v49, 0
    v_dot2_f32_bf16 v151, v95, v48, 0
    v_permlane32_swap_b32 v128, v132
    v_permlane32_swap_b32 v129, v133
    v_permlane32_swap_b32 v130, v134
    v_permlane32_swap_b32 v131, v135
    v_add_f32 v128, v128, v132
    v_add_f32 v129, v129, v133
    v_add_f32 v130, v130, v134
    v_add_f32 v131, v131, v135
    s_nop 0
    v_permlane16_swap_b32 v128, v130
    v_permlane16_swap_b32 v129, v131
    v_add_f32 v128, v128, v130
    v_add_f32 v129, v129, v131
    s_nop 0
    v_add_f32_dpp v128, v128, v128 row_ror:8 row_mask:0xf bank_mask:0xf
    v_add_f32_dpp v129, v129, v129 row_ror:8 row_mask:0xf bank_mask:0xf
    v_permlane32_swap_b32 v144, v148
    v_permlane32_swap_b32 v145, v149
    v_permlane32_swap_b32 v146, v150
    v_permlane32_swap_b32 v147, v151
    v_add_f32 v144, v144, v148
    v_add_f32 v145, v145, v149
    v_add_f32 v146, v146, v150
    v_add_f32 v147, v147, v151
    s_nop 0
    v_permlane16_swap_b32 v144, v146
    v_permlane16_swap_b32 v145, v147
    v_add_f32 v144, v144, v146
    v_add_f32 v145, v145, v147
    s_nop 0
    v_add_f32_dpp v144, v144, v144 row_ror:8 row_mask:0xf bank_mask:0xf
    v_add_f32_dpp v145, v145, v145 row_ror:8 row_mask:0xf bank_mask:0xf
    ds_write_b64 v52, v[128:129] offset:30976
    ds_write_b64 v52, v[144:145] offset:31488
L_h1_7:
    s_nop 4
    buffer_load_dwordx4 v[100:103], v54, s[64:67], s7 offen sc1
    s_waitcnt vmcnt(0)
    v_max3_u32 v7, v100, v101, v102
    v_max_u32 v7, v7, v103
    v_cmp_eq_u32 vcc, -1, v7
    s_sub_u32 s81, s81, 1
    s_cbranch_scc1 L_h1ok_8
    s_cmp_eq_u64 vcc, 0
    s_cbranch_scc0 L_h1_7
L_h1ok_8:
    s_nop 4
    v_mov_b32_dpp v6, v103 row_ror:8 row_mask:0xf bank_mask:0xf
    s_mov_b32 vcc_lo, 0xff00ff00
    s_mov_b32 vcc_hi, 0xff00ff00
    v_cndmask_b32 v104, v103, v6, vcc
    v_cndmask_b32 v105, v6, v103, vcc
    v_mov_b32 v5, v104
    s_nop 1
    v_max_f32_dpp v5, v5, v5 quad_perm:[1,0,3,2] row_mask:0xf bank_mask:0xf
    s_nop 1
    v_max_f32_dpp v5, v5, v5 quad_perm:[2,3,0,1] row_mask:0xf bank_mask:0xf
    s_nop 1
    v_max_f32_dpp v5, v5, v5 row_half_mirror row_mask:0xf bank_mask:0xf
    v_sub_f32 v104, v104, v5
    v_mul_f32 v104, 0x3fb8aa3b, v104
    v_exp_f32 v104, v104
    s_nop 0
    v_mul_f32 v105, v105, v104
    v_mul_f32 v100, v100, v104
    v_mul_f32 v101, v101, v104
    v_mul_f32 v102, v102, v104
    v_add_f32_dpp v105, v105, v105 quad_perm:[1,0,3,2] row_mask:0xf bank_mask:0xf
    v_add_f32_dpp v100, v100, v100 quad_perm:[1,0,3,2] row_mask:0xf bank_mask:0xf
    v_add_f32_dpp v101, v101, v101 quad_perm:[1,0,3,2] row_mask:0xf bank_mask:0xf
    v_add_f32_dpp v102, v102, v102 quad_perm:[1,0,3,2] row_mask:0xf bank_mask:0xf
    v_add_f32_dpp v105, v105, v105 quad_perm:[2,3,0,1] row_mask:0xf bank_mask:0xf
    v_add_f32_dpp v100, v100, v100 quad_perm:[2,3,0,1] row_mask:0xf bank_mask:0xf
    v_add_f32_dpp v101, v101, v101 quad_perm:[2,3,0,1] row_mask:0xf bank_mask:0xf
    v_add_f32_dpp v102, v102, v102 quad_perm:[2,3,0,1] row_mask:0xf bank_mask:0xf
    v_add_f32_dpp v105, v105, v105 row_half_mirror row_mask:0xf bank_mask:0xf
    v_add_f32_dpp v100, v100, v100 row_half_mirror row_mask:0xf bank_mask:0xf
    v_add_f32_dpp v101, v101, v101 row_half_mirror row_mask:0xf bank_mask:0xf
    v_add_f32_dpp v102, v102, v102 row_half_mirror row_mask:0xf bank_mask:0xf
    v_rcp_f32 v105, v105
    s_nop 0
    v_mul_f32 v100, v100, v105
    v_mul_f32 v101, v101, v105
    v_mul_f32 v102, v102, v105
    v_cvt_pk_bf16_f32 v5, v100, v101
    v_cvt_pk_bf16_f32 v6, v102, v102
    v_and_b32 v109, 0xffff, v5
    v_lshlrev_b32 v106, 16, v5
    v_lshrrev_b32 v110, 16, v5
    v_and_b32 v107, 0xffff0000, v5
    v_and_b32 v111, 0xffff, v6
    v_and_b32 v108, 0xffff0000, v6
    v_dot2_f32_bf16 v120, v64, v109, 0
    v_dot2_f32_bf16 v121, v64, v106, 0
    v_dot2_f32_bf16 v122, v65, v109, 0
    v_dot2_f32_bf16 v123, v65, v106, 0
    v_dot2_f32_bf16 v124, v66, v109, 0
    v_dot2_f32_bf16 v125, v66, v106, 0
    v_dot2_f32_bf16 v126, v67, v109, 0
    v_dot2_f32_bf16 v127, v67, v106, 0
    v_dot2_f32_bf16 v120, v68, v110, v120
    v_dot2_f32_bf16 v121, v68, v107, v121
    v_dot2_f32_bf16 v122, v69, v110, v122
    v_dot2_f32_bf16 v123, v69, v107, v123
    v_dot2_f32_bf16 v124, v70, v110, v124
    v_dot2_f32_bf16 v125, v70, v107, v125
    v_dot2_f32_bf16 v126, v71, v110, v126
    v_dot2_f32_bf16 v127, v71, v107, v127
    v_dot2_f32_bf16 v120, v72, v111, v120
    v_dot2_f32_bf16 v121, v72, v108, v121
    v_dot2_f32_bf16 v122, v73, v111, v122
    v_dot2_f32_bf16 v123, v73, v108, v123
    v_dot2_f32_bf16 v124, v74, v111, v124
    v_dot2_f32_bf16 v125, v74, v108, v125
    v_dot2_f32_bf16 v126, v75, v111, v126
    v_dot2_f32_bf16 v127, v75, v108, v127
    s_cmp_eq_u32 s12, 0
    s_cbranch_scc1 L_nox_9
    v_dot2_f32_bf16 v136, v80, v109, 0
    v_dot2_f32_bf16 v137, v80, v106, 0
    v_dot2_f32_bf16 v138, v81, v109, 0
    v_dot2_f32_bf16 v139, v81, v106, 0
    v_dot2_f32_bf16 v140, v82, v109, 0
    v_dot2_f32_bf16 v141, v82, v106, 0
    v_dot2_f32_bf16 v142, v83, v109, 0
    v_dot2_f32_bf16 v143, v83, v106, 0
    v_dot2_f32_bf16 v136, v84, v110, v136
    v_dot2_f32_bf16 v137, v84, v107, v137
    v_dot2_f32_bf16 v138, v85, v110, v138
    v_dot2_f32_bf16 v139, v85, v107, v139
    v_dot2_f32_bf16 v140, v86, v110, v140
    v_dot2_f32_bf16 v141, v86, v107, v141
    v_dot2_f32_bf16 v142, v87, v110, v142
    v_dot2_f32_bf16 v143, v87, v107, v143
    v_dot2_f32_bf16 v136, v88, v111, v136
    v_dot2_f32_bf16 v137, v88, v108, v137
    v_dot2_f32_bf16 v138, v89, v111, v138
    v_dot2_f32_bf16 v139, v89, v108, v139
    v_dot2_f32_bf16 v140, v90, v111, v140
    v_dot2_f32_bf16 v141, v90, v108, v141
    v_dot2_f32_bf16 v142, v91, v111, v142
    v_dot2_f32_bf16 v143, v91, v108, v143
    v_permlane32_swap_b32 v136, v140
    v_permlane32_swap_b32 v137, v141
    v_permlane32_swap_b32 v138, v142
    v_permlane32_swap_b32 v139, v143
    v_add_f32 v136, v136, v140
    v_add_f32 v137, v137, v141
    v_add_f32 v138, v138, v142
    v_add_f32 v139, v139, v143
    s_nop 0
    v_permlane16_swap_b32 v136, v138
    v_permlane16_swap_b32 v137, v139
    v_add_f32 v136, v136, v138
    v_add_f32 v137, v137, v139
    s_nop 0
    v_add_f32_dpp v136, v136, v136 row_ror:8 row_mask:0xf bank_mask:0xf
    v_add_f32_dpp v137, v137, v137 row_ror:8 row_mask:0xf bank_mask:0xf
    ds_write_b64 v52, v[136:137] offset:31232
L_nox_9:
    s_nop 4
    v_permlane32_swap_b32 v120, v124
    v_permlane32_swap_b32 v121, v125
    v_permlane32_swap_b32 v122, v126
    v_permlane32_swap_b32 v123, v127
    v_add_f32 v120, v120, v124
    v_add_f32 v121, v121, v125
    v_add_f32 v122, v122, v126
    v_add_f32 v123, v123, v127
    s_nop 0
    v_permlane16_swap_b32 v120, v122
    v_permlane16_swap_b32 v121, v123
    v_add_f32 v120, v120, v122
    v_add_f32 v121, v121, v123
    s_nop 0
    v_add_f32_dpp v120, v120, v120 row_ror:8 row_mask:0xf bank_mask:0xf
    v_add_f32_dpp v121, v121, v121 row_ror:8 row_mask:0xf bank_mask:0xf
    ds_write_b64 v52, v[120:121] offset:30720
    v_lshlrev_b32 v7, 4, v2
    s_waitcnt lgkmcnt(0)
    s_barrier
    s_lshl_b32 s6, s85, 15
    s_add_u32 s6, s6, 786432
    s_cmp_eq_u32 s3, 1
    s_cbranch_scc1 L_red
    s_cmp_lg_u32 s3, 0
    s_cbranch_scc1 L_end
    ds_read_b128 v[96:99], v7 offset:30720
    ds_read_b128 v[100:103], v7 offset:31744
    ds_read_b128 v[104:107], v7 offset:32768
    ds_read_b128 v[108:111], v7 offset:33792
    ds_read_b128 v[112:115], v7 offset:34816
    ds_read_b128 v[116:119], v7 offset:35840
    ds_read_b128 v[120:123], v7 offset:36864
    ds_read_b128 v[124:127], v7 offset:37888
    s_lshl_b32 s7, s84, 10
    s_add_u32 s7, s7, s6
    s_add_u32 s82, s7, 1048576
    s_cmp_eq_u32 s12, 1
    s_cselect_b32 s83, -1, 0
    s_mov_b32 exec_hi, s83
    s_waitcnt lgkmcnt(0)
    v_add_f32 v96, v96, v112
    v_add_f32 v97, v97, v113
    v_add_f32 v98, v98, v114
    v_add_f32 v99, v99, v115
    v_add_f32 v100, v100, v116
    v_add_f32 v101, v101, v117
    v_add_f32 v102, v102, v118
    v_add_f32 v103, v103, v119
    v_add_f32 v104, v104, v120
    v_add_f32 v105, v105, v121
    v_add_f32 v106, v106, v122
    v_add_f32 v107, v107, v123
    v_add_f32 v108, v108, v124
    v_add_f32 v109, v109, v125
    v_add_f32 v110, v110, v126
    v_add_f32 v111, v111, v127
    v_add_f32 v96, v96, v104
    v_add_f32 v97, v97, v105
    v_add_f32 v98, v98, v106
    v_add_f32 v99, v99, v107
    v_add_f32 v100, v100, v108
    v_add_f32 v101, v101, v109
    v_add_f32 v102, v102, v110
    v_add_f32 v103, v103, v111
    v_add_f32 v96, v96, v100
    v_add_f32 v97, v97, v101
    v_add_f32 v98, v98, v102
    v_add_f32 v99, v99, v103
    v_min_u32 v96, -2, v96
    v_min_u32 v97, -2, v97
    v_min_u32 v98, -2, v98
    v_min_u32 v99, -2, v99
    buffer_store_dwordx4 v[96:99], v7, s[64:67], s7 offen
    buffer_store_dwordx4 v[96:99], v7, s[64:67], s82 offen sc1
    s_mov_b64 exec, -1
    s_branch L_end
L_red:
    s_nop 4
    s_sub_u32 s82, 1, s12
    s_and_b32 s82, s82, s14
    s_cmp_eq_u32 s82, 1
    s_cbranch_scc1 L_fin
    v_and_b32 v5, 31, v2
    v_lshlrev_b32 v5, 10, v5
    v_lshrrev_b32 v6, 5, v2
    v_lshl_add_u32 v5, v6, 8, v5
    s_lshl_b32 s7, s15, 4
    s_add_u32 s7, s7, s6
    s_lshl_b32 s82, s14, 9
    s_add_u32 s7, s7, s82
    s_add_u32 s82, s7, 1048576
    s_mov_b32 s81, 65536
    v_mov_b32 v104, -1
    v_mov_b32 v105, -1
    v_mov_b32 v106, -1
    v_mov_b32 v107, -1
L_h2_10:
    s_nop 4
    buffer_load_dwordx4 v[100:103], v5, s[64:67], s7 offen sc1
    s_and_b32 s83, s81, 3
    s_cmp_lg_u32 s83, 0
    s_cbranch_scc1 L_h2a_12
    buffer_load_dwordx4 v[104:107], v5, s[64:67], s82 offen sc1
L_h2a_12:
    s_nop 4
    s_waitcnt vmcnt(0)
    v_min_u32 v100, v100, v104
    v_min_u32 v101, v101, v105
    v_min_u32 v102, v102, v106
    v_min_u32 v103, v103, v107
    v_max3_u32 v7, v100, v101, v102
    v_max_u32 v7, v7, v103
    v_cmp_eq_u32 vcc, -1, v7
    s_sub_u32 s81, s81, 1
    s_cbranch_scc1 L_h2ok_11
    s_cmp_eq_u64 vcc, 0
    s_cbranch_scc0 L_h2_10
L_h2ok_11:
    s_nop 4
    v_permlane16_swap_b32 v100, v101
    v_permlane16_swap_b32 v102, v103
    v_add_f32 v100, v100, v101
    v_add_f32 v102, v102, v103
    s_nop 0
    v_add_f32_dpp v100, v100, v100 quad_perm:[1,0,3,2] row_mask:0xf bank_mask:0xf
    v_add_f32_dpp v102, v102, v102 quad_perm:[1,0,3,2] row_mask:0xf bank_mask:0xf
    s_nop 0
    v_add_f32_dpp v100, v100, v100 quad_perm:[2,3,0,1] row_mask:0xf bank_mask:0xf
    v_add_f32_dpp v102, v102, v102 quad_perm:[2,3,0,1] row_mask:0xf bank_mask:0xf
    s_nop 0
    v_add_f32_dpp v100, v100, v100 row_half_mirror row_mask:0xf bank_mask:0xf
    v_add_f32_dpp v102, v102, v102 row_half_mirror row_mask:0xf bank_mask:0xf
    s_nop 0
    v_add_f32_dpp v100, v100, v100 row_mirror row_mask:0xf bank_mask:0xf
    v_add_f32_dpp v102, v102, v102 row_mirror row_mask:0xf bank_mask:0xf
    v_mov_b32 v101, v100
    v_mov_b32 v103, v102
    s_nop 0
    v_permlane32_swap_b32 v100, v101
    v_permlane32_swap_b32 v102, v103
    v_lshlrev_b32 v20, 16, v20
    v_lshlrev_b32 v21, 16, v21
    v_cvt_pk_bf16_f32 v5, v100, v101
    v_lshlrev_b32 v100, 16, v5
    v_and_b32 v101, 0xffff0000, v5
    v_mul_f32 v5, 0xbfb8aa3b, v101
    v_exp_f32 v5, v5
    s_nop 0
    v_add_f32 v5, 1.0, v5
    v_rcp_f32 v5, v5
    s_nop 0
    v_mul_f32 v101, v101, v5
    v_cvt_pk_bf16_f32 v101, v101, v101
    v_and_b32 v101, 0xffff0000, v101
    v_mul_f32 v100, v100, v101
    v_cvt_pk_bf16_f32 v100, v100, v100
    v_and_b32 v100, 0xffff0000, v100
    v_add_f32 v100, v100, v20
    v_cvt_pk_bf16_f32 v100, v100, v100
    v_cvt_pk_bf16_f32 v5, v102, v103
    v_lshlrev_b32 v102, 16, v5
    v_and_b32 v103, 0xffff0000, v5
    v_mul_f32 v5, 0xbfb8aa3b, v103
    v_exp_f32 v5, v5
    s_nop 0
    v_add_f32 v5, 1.0, v5
    v_rcp_f32 v5, v5
    s_nop 0
    v_mul_f32 v103, v103, v5
    v_cvt_pk_bf16_f32 v103, v103, v103
    v_and_b32 v103, 0xffff0000, v103
    v_mul_f32 v102, v102, v103
    v_cvt_pk_bf16_f32 v102, v102, v102
    v_and_b32 v102, 0xffff0000, v102
    v_add_f32 v102, v102, v21
    v_cvt_pk_bf16_f32 v102, v102, v102
    s_mov_b32 exec_lo, 0x00010001
    s_mov_b32 exec_hi, 0
    buffer_store_short v100, v9, s[72:75], 0 offen
    buffer_store_short v102, v9, s[72:75], 0 offen offset:4
    s_mov_b64 exec, -1
L_fin:
    s_nop 4
L_end:
    s_nop 4
    s_endpgm
.section .rodata,"a"
.p2align 6
.amdhsa_kernel recurrent_scan__sliding_block_cached__geglu_ffn__decode_kernel
  .amdhsa_next_free_vgpr 256
  .amdhsa_next_free_sgpr 102
  .amdhsa_accum_offset 256
  .amdhsa_group_segment_fixed_size 0
  .amdhsa_kernarg_size 96
  .amdhsa_user_sgpr_count 2
  .amdhsa_user_sgpr_kernarg_segment_ptr 1
  .amdhsa_system_sgpr_workgroup_id_x 1
.end_amdhsa_kernel
```
